```python
import torch

def _softmax(x, axis=-1):
    return torch.softmax(x, dim=axis)
def _gelu(x):
    return torch.nn.functional.gelu(x, approximate="tanh")
def _silu(x):
    return torch.nn.functional.silu(x)
def _sigmoid(x):
    return torch.sigmoid(x)
def _layernorm(x, axis=-1, eps=1e-5):
    m = x.mean(dim=axis, keepdim=True)
    v = x.var(dim=axis, keepdim=True, unbiased=False)
    return (x - m) / torch.sqrt(v + eps)
def _scatter_add(tgt, idx, src, axis=0):
    return tgt.clone().index_add_(axis, idx, src)
def _segment_sum(src, seg, n):
    out = torch.zeros((n,) + src.shape[1:], dtype=src.dtype)
    return out.index_add_(0, seg, src)
def _pad(x, pw):
    flat = tuple(v for pair in reversed(pw) for v in pair)
    return torch.nn.functional.pad(x, flat)

kernel_name = 'recurrent_scan__ssm_conv_s4d__geglu_ffn__prompt'

def setup_inputs():

    _w = (lambda a: (lambda t: t.to(torch.bfloat16) if t.is_floating_point() else t)(torch.as_tensor(a)))
    def _A_setup():
        Bsz, L, D, N = 1, 2048, 640, 128
        return {
            "u": _w((lambda *s: torch.randn(*s, dtype=torch.bfloat16) * 0.05)(Bsz, L, D)),
            "log_A_real": _w((lambda *s: torch.randn(*s, dtype=torch.bfloat16) * 3.2)(D, N) * 0.5),
            "A_imag": _w((lambda *s: torch.randn(*s, dtype=torch.bfloat16) * 0.05)(D, N) * 3.14),
            "C_real": _w((lambda *s: torch.randn(*s, dtype=torch.bfloat16) * 0.1)(D, N) / N ** 0.5),
            "C_imag": _w((lambda *s: torch.randn(*s, dtype=torch.bfloat16) * 0.1)(D, N) / N ** 0.5),
            "log_dt": _w((lambda *s: torch.randn(*s, dtype=torch.bfloat16) * 0.05)(D) * 0.5 - 4.0),
            "D_skip": _w((lambda *s: torch.randn(*s, dtype=torch.bfloat16) * 0.05)(D)),
        }
    _A_in = _A_setup()

    def _B_setup():
        B, S, D, F = 1, 2048, 640, 1728
        return {
            "x": _w((lambda *s: torch.randn(*s, dtype=torch.bfloat16) * 0.05)(B, S, D)),
            "w_gate": _w((lambda *s: torch.randn(*s, dtype=torch.bfloat16) * 0.05)(D, F)),
            "w_up": _w((lambda *s: torch.randn(*s, dtype=torch.bfloat16) * 0.05)(D, F)),
            "w_down": _w((lambda *s: torch.randn(*s, dtype=torch.bfloat16) * 0.05)(F, D)),
        }
    _B_in = _B_setup()

    return {
        "A_u": _A_in["u"],
        "A_log_A_real": _A_in["log_A_real"],
        "A_A_imag": _A_in["A_imag"],
        "A_C_real": _A_in["C_real"],
        "A_C_imag": _A_in["C_imag"],
        "A_log_dt": _A_in["log_dt"],
        "A_D_skip": _A_in["D_skip"],
        "B_x": _B_in["x"],
        "B_w_gate": _B_in["w_gate"],
        "B_w_up": _B_in["w_up"],
        "B_w_down": _B_in["w_down"],
    }

def reference(A_u, A_log_A_real, A_A_imag, A_C_real, A_C_imag, A_log_dt, A_D_skip, B_x, B_w_gate, B_w_up, B_w_down):
    def _A_ref(u, log_A_real, A_imag, C_real, C_imag, log_dt, D_skip):
        L = u.shape[1]
        dt = torch.exp(log_dt)
        A = -torch.exp(log_A_real) + 1j * A_imag
        C = (C_real + 1j * C_imag) * dt[:, None]
        pos = (lambda x, dt: x.to(dt))(torch.arange(L), log_dt.dtype)
        P = torch.exp((A * dt[:, None])[:, :, None] * pos[None, None, :])
        K = 2.0 * torch.einsum("dn,dnl->dl", C, P).real
        L2 = 2 * L
        u_t = (lambda x, *d: x.permute(*d))(u, 0, 2, 1)
        Kf = (lambda x, *a, **k: torch.fft.rfft(x.float(), *a, **k))(K, L2)
        Uf = (lambda x, *a, **k: torch.fft.rfft(x.float(), *a, **k))(u_t, L2)
        y = (lambda x, *a, **k: torch.fft.irfft(x, *a, **k).to(torch.bfloat16))(Uf * Kf[None, :, :], L2)[:, :, :L]
        y = (lambda x, *d: x.permute(*d))(y, 0, 2, 1)
        return y + u * D_skip[None, None, :]

    def _B_ref(x, w_gate, w_up, w_down):
        return (_gelu(x @ w_gate) * (x @ w_up)) @ w_down

    x = A_u
    xn = _layernorm(x, axis=-1)
    s = _A_ref(xn, A_log_A_real, A_A_imag, A_C_real, A_C_imag, A_log_dt, A_D_skip)
    g = _silu(_B_ref(xn, B_w_gate, B_w_up, B_w_down))
    return x + s * g
```

```asm
; @launch grid=(256,1,1) block=(512,1,1) lds=163840
.amdgcn_target "amdgcn-amd-amdhsa--gfx950"
.text
.globl recurrent_scan__ssm_conv_s4d__geglu_ffn__prompt_kernel
.p2align 8
.type recurrent_scan__ssm_conv_s4d__geglu_ffn__prompt_kernel,@function
recurrent_scan__ssm_conv_s4d__geglu_ffn__prompt_kernel:
    s_cmp_ge_u32 s2, 256
    s_cbranch_scc1 L_END
    s_load_dwordx16 s[16:31], s[0:1], 0
    s_load_dwordx8 s[32:39], s[0:1], 64
    s_load_dwordx4 s[40:43], s[0:1], 96
    s_getpc_b64 s[4:5]
    v_lshlrev_b32 v2, 7, v0
    v_min_u32 v2, L_CODE_END-recurrent_scan__ssm_conv_s4d__geglu_ffn__prompt_kernel-64, v2
    global_load_dword v31, v2, s[4:5]
    v_lshrrev_b32 v1, 6, v0
    v_and_b32 v0, 63, v0
    v_readfirstlane_b32 s3, v1
    v_lshlrev_b32 v1, 2, v0
    v_add_u32 v1, 163072, v1
    v_mov_b32 v2, 0
    ds_write_b32 v1, v2
    s_and_b32 s72, s2, 7
    s_lshr_b32 s73, s2, 3
    s_mul_i32 s72, s72, 27
    s_add_u32 s72, s72, s73
    s_cmp_ge_u32 s72, 108
    s_cselect_b32 s73, 108, 0
    s_cselect_b32 s74, 4, 0
    s_sub_u32 s72, s72, s73
    s_lshr_b32 s69, s72, 2
    s_and_b32 s72, s72, 3
    s_add_u32 s68, s72, s74
    s_mul_i32 s70, s2, 3
    s_waitcnt lgkmcnt(0)
    s_barrier
    s_mov_b32 s44, s42
    s_mov_b32 s45, s43
    s_mov_b32 s46, 33554432
    s_mov_b32 s47, 0x00020000
    s_mov_b32 s48, s40
    s_mov_b32 s49, s41
    s_mov_b32 s50, 256
    s_mov_b32 s51, 0x00020000
    s_cmp_ge_u32 s2, 216
    s_cbranch_scc1 L_PRE
    s_cmp_lt_u32 s3, 1
    s_cbranch_scc1 L_G1Z
    s_cmp_lg_u32 s3, 4
    s_cbranch_scc1 L_KTASK
L_LOADER:
    s_setprio 2
    s_mov_b32 s52, s16
    s_mov_b32 s53, s17
    s_mov_b32 s54, 2621440
    s_mov_b32 s55, 0x00020000
    s_mov_b32 s56, s32
    s_mov_b32 s57, s33
    s_mov_b32 s58, 2211840
    s_mov_b32 s59, 0x00020000
    s_mov_b32 s60, s34
    s_mov_b32 s61, s35
    s_mov_b32 s62, 2211840
    s_mov_b32 s63, 0x00020000
    v_lshrrev_b32 v4, 3, v0
    v_and_b32 v5, 7, v0
    v_lshrrev_b32 v6, 4, v0
    v_xor_b32 v7, v5, v6
    v_mul_u32_u24 v8, 1280, v4
    v_lshl_add_u32 v10, v7, 4, v8
    v_xor_b32 v11, 64, v10
    v_and_b32 v6, 1, v6
    v_lshlrev_b32 v6, 1, v6
    v_xor_b32 v7, v5, v6
    v_mul_u32_u24 v8, 3456, v4
    v_lshl_add_u32 v12, v7, 4, v8
    v_xor_b32 v13, 64, v12
    s_mul_i32 s77, s68, 327680
    s_lshl_b32 s78, s69, 7
    s_mov_b32 s79, 0
    s_mov_b32 s80, 98304
    v_mov_b32 v14, 163072
    v_add_u32 v32, 0, v10
    v_add_u32 v33, 9216, v11
    v_add_u32 v34, 18432, v10
    v_add_u32 v35, 27648, v11
    v_add_u32 v36, 40960, v10
    v_add_u32 v37, 50176, v11
    v_add_u32 v38, 59392, v10
    v_add_u32 v39, 68608, v11
    v_add_u32 v40, 81920, v10
    v_add_u32 v41, 91136, v11
    v_add_u32 v42, 100352, v10
    v_add_u32 v43, 109568, v11
    v_add_u32 v44, 122880, v10
    v_add_u32 v45, 132096, v11
    v_add_u32 v46, 141312, v10
    v_add_u32 v47, 150528, v11
    v_add_u32 v48, 163840, v10
    v_add_u32 v49, 173056, v11
    v_add_u32 v50, 182272, v10
    v_add_u32 v51, 191488, v11
    v_add_u32 v52, 204800, v10
    v_add_u32 v53, 214016, v11
    v_add_u32 v54, 223232, v10
    v_add_u32 v55, 232448, v11
    v_add_u32 v56, 245760, v10
    v_add_u32 v57, 254976, v11
    v_add_u32 v58, 264192, v10
    v_add_u32 v59, 273408, v11
    v_add_u32 v60, 286720, v10
    v_add_u32 v61, 295936, v11
    v_add_u32 v62, 305152, v10
    v_add_u32 v63, 314368, v11
    v_add_u32 v64, 0, v12
    v_add_u32 v65, 26624, v13
    v_add_u32 v66, 53248, v12
    v_add_u32 v67, 79872, v13
    v_add_u32 v68, 110592, v12
    v_add_u32 v69, 137216, v13
    v_add_u32 v70, 163840, v12
    v_add_u32 v71, 190464, v13
    v_add_u32 v72, 0, v12
    v_add_u32 v73, 26624, v13
    v_add_u32 v74, 53248, v12
    v_add_u32 v75, 79872, v13
    v_add_u32 v76, 110592, v12
    v_add_u32 v77, 137216, v13
    v_add_u32 v78, 163840, v12
    v_add_u32 v79, 190464, v13
    s_getpc_b64 s[64:65]
L_TBREF2:
    s_add_u32 s64, s64, L_TABLE-L_TBREF2
    s_addc_u32 s65, s65, 0
    s_mov_b32 s66, 384
    s_mov_b32 s67, 0x00020000
    v_mov_b32 v18, 0
    s_add_u32 s82, s68, s69
    s_mul_i32 s84, s82, 86
    s_lshr_b32 s84, s84, 8
    s_mul_i32 s84, s84, 3
    s_sub_u32 s76, s82, s84
    s_mul_i32 s76, s76, 3
    s_add_u32 s76, s76, 1
    s_mov_b32 s85, 0
    s_mov_b32 s81, 0
    s_mov_b32 s83, 0
    s_mov_b32 s84, 0
    v_mov_b32 v16, 163088
    s_branch L_LDX
L_LDLOOP:
    s_waitcnt lgkmcnt(0)
    v_min_u32 v20, v20, v21
    v_min3_u32 v20, v20, v22, v23
    s_nop 0
    v_readfirstlane_b32 s72, v20
    s_nop 1
    s_cmp_ge_u32 s72, s84
    s_cbranch_scc1 L_LDX
    v_mov_b32 v17, 163088
    s_mov_b32 s73, 200000
LW_1:
    ds_read_b128 v[20:23], v17
    s_waitcnt lgkmcnt(0)
    v_min_u32 v20, v20, v21
    v_min3_u32 v20, v20, v22, v23
    s_nop 0
    v_readfirstlane_b32 s72, v20
    s_nop 1
    s_cmp_ge_u32 s72, s84
    s_cbranch_scc1 LWD_2
    s_sub_u32 s73, s73, 1
    s_cmp_eq_u32 s73, 0
    s_cbranch_scc1 LWD_2
    s_sleep 0
    s_branch LW_1
LWD_2:
L_LDX:
    s_add_u32 s83, s83, 1
    s_cmp_eq_u32 s83, 10
    s_cselect_b32 s86, 11, s83
    s_lshl_b32 s86, s86, 5
    s_add_u32 m0, s79, 0
    s_nop 0
    buffer_load_dwordx4 v32, s[52:55], s77 offen offset:0 lds
    buffer_load_dwordx4 v33, s[52:55], s77 offen offset:1024 lds
    buffer_load_dwordx4 v34, s[52:55], s77 offen offset:2048 lds
    buffer_load_dwordx4 v35, s[52:55], s77 offen offset:3072 lds
    s_add_u32 m0, s79, 4096
    s_nop 0
    buffer_load_dwordx4 v36, s[52:55], s77 offen offset:0 lds
    buffer_load_dwordx4 v37, s[52:55], s77 offen offset:1024 lds
    buffer_load_dwordx4 v38, s[52:55], s77 offen offset:2048 lds
    buffer_load_dwordx4 v39, s[52:55], s77 offen offset:3072 lds
    s_add_u32 m0, s79, 8192
    s_nop 0
    buffer_load_dwordx4 v40, s[52:55], s77 offen offset:0 lds
    buffer_load_dwordx4 v41, s[52:55], s77 offen offset:1024 lds
    buffer_load_dwordx4 v42, s[52:55], s77 offen offset:2048 lds
    buffer_load_dwordx4 v43, s[52:55], s77 offen offset:3072 lds
    s_add_u32 m0, s79, 12288
    s_nop 0
    buffer_load_dwordx4 v44, s[52:55], s77 offen offset:0 lds
    buffer_load_dwordx4 v45, s[52:55], s77 offen offset:1024 lds
    buffer_load_dwordx4 v46, s[52:55], s77 offen offset:2048 lds
    buffer_load_dwordx4 v47, s[52:55], s77 offen offset:3072 lds
    s_add_u32 m0, s79, 16384
    s_nop 0
    buffer_load_dwordx4 v48, s[52:55], s77 offen offset:0 lds
    buffer_load_dwordx4 v49, s[52:55], s77 offen offset:1024 lds
    buffer_load_dwordx4 v50, s[52:55], s77 offen offset:2048 lds
    buffer_load_dwordx4 v51, s[52:55], s77 offen offset:3072 lds
    s_add_u32 m0, s79, 20480
    s_nop 0
    buffer_load_dwordx4 v52, s[52:55], s77 offen offset:0 lds
    buffer_load_dwordx4 v53, s[52:55], s77 offen offset:1024 lds
    buffer_load_dwordx4 v54, s[52:55], s77 offen offset:2048 lds
    buffer_load_dwordx4 v55, s[52:55], s77 offen offset:3072 lds
    ds_read_b128 v[20:23], v16 offset:16
    s_add_u32 m0, s79, 24576
    s_nop 0
    buffer_load_dwordx4 v56, s[52:55], s77 offen offset:0 lds
    buffer_load_dwordx4 v57, s[52:55], s77 offen offset:1024 lds
    buffer_load_dwordx4 v58, s[52:55], s77 offen offset:2048 lds
    buffer_load_dwordx4 v59, s[52:55], s77 offen offset:3072 lds
    s_add_u32 m0, s79, 28672
    s_nop 0
    buffer_load_dwordx4 v60, s[52:55], s77 offen offset:0 lds
    buffer_load_dwordx4 v61, s[52:55], s77 offen offset:1024 lds
    buffer_load_dwordx4 v62, s[52:55], s77 offen offset:2048 lds
    buffer_load_dwordx4 v63, s[52:55], s77 offen offset:3072 lds
    s_mov_b32 m0, 163072
    s_mov_b64 exec, 1
    buffer_load_dword v18, s[64:67], s86 offen offset:0 lds
    s_mov_b64 exec, -1
    s_waitcnt lgkmcnt(0)
    v_min_u32 v20, v20, v21
    v_min3_u32 v20, v20, v22, v23
    s_nop 0
    v_readfirstlane_b32 s72, v20
    s_nop 1
    s_cmp_ge_u32 s72, s84
    s_cbranch_scc1 L_LDW
    v_mov_b32 v17, 163104
    s_mov_b32 s73, 200000
LW_3:
    ds_read_b128 v[20:23], v17
    s_waitcnt lgkmcnt(0)
    v_min_u32 v20, v20, v21
    v_min3_u32 v20, v20, v22, v23
    s_nop 0
    v_readfirstlane_b32 s72, v20
    s_nop 1
    s_cmp_ge_u32 s72, s84
    s_cbranch_scc1 LWD_4
    s_sub_u32 s73, s73, 1
    s_cmp_eq_u32 s73, 0
    s_cbranch_scc1 LWD_4
    s_sleep 0
    s_branch LW_3
LWD_4:
L_LDW:
    s_add_u32 m0, s80, 0
    s_nop 0
    buffer_load_dwordx4 v64, s[56:59], s78 offen offset:0 lds
    buffer_load_dwordx4 v65, s[56:59], s78 offen offset:1024 lds
    buffer_load_dwordx4 v66, s[56:59], s78 offen offset:2048 lds
    buffer_load_dwordx4 v67, s[56:59], s78 offen offset:3072 lds
    s_add_u32 m0, s80, 8192
    s_nop 0
    buffer_load_dwordx4 v72, s[60:63], s78 offen offset:0 lds
    buffer_load_dwordx4 v73, s[60:63], s78 offen offset:1024 lds
    buffer_load_dwordx4 v74, s[60:63], s78 offen offset:2048 lds
    buffer_load_dwordx4 v75, s[60:63], s78 offen offset:3072 lds
    ds_read_b128 v[20:23], v16
    s_add_u32 m0, s80, 4096
    s_nop 0
    buffer_load_dwordx4 v68, s[56:59], s78 offen offset:0 lds
    buffer_load_dwordx4 v69, s[56:59], s78 offen offset:1024 lds
    buffer_load_dwordx4 v70, s[56:59], s78 offen offset:2048 lds
    buffer_load_dwordx4 v71, s[56:59], s78 offen offset:3072 lds
    s_add_u32 m0, s80, 12288
    s_nop 0
    buffer_load_dwordx4 v76, s[60:63], s78 offen offset:0 lds
    buffer_load_dwordx4 v77, s[60:63], s78 offen offset:1024 lds
    buffer_load_dwordx4 v78, s[60:63], s78 offen offset:2048 lds
    buffer_load_dwordx4 v79, s[60:63], s78 offen offset:3072 lds
    s_mov_b32 m0, 163072
    s_mov_b64 exec, 1
    buffer_load_dword v18, s[64:67], s86 offen offset:4 lds
    s_mov_b64 exec, -1
    s_sub_u32 s82, s76, s85
    s_mov_b32 s85, s76
    s_mul_i32 s84, s82, 221184
    s_add_u32 s78, s78, s84
    s_lshl_b32 s82, s82, 7
    s_add_u32 s77, s77, s82
    s_add_u32 s76, s76, 1
    s_cmp_eq_u32 s76, 10
    s_cselect_b32 s76, 1, s76
    s_cmp_eq_u32 s81, 2
    s_cselect_b32 s82, -2, 1
    s_lshl_b32 s82, s82, 14
    s_add_u32 s80, s80, s82
    s_lshl_b32 s82, s82, 1
    s_add_u32 s79, s79, s82
    s_add_u32 s81, s81, 1
    s_cmp_eq_u32 s81, 3
    s_cselect_b32 s81, 0, s81
    s_sub_u32 s84, s83, 2
    s_max_i32 s84, s84, 0
    s_cmp_le_u32 s83, 9
    s_cbranch_scc1 L_LDLOOP
    s_setprio 0
    s_branch L_HOUSE
L_G1Z:
    v_mov_b32 v128, 0
    v_mov_b32 v129, 0
    v_mov_b32 v130, 0
    v_mov_b32 v131, 0
    v_mov_b32 v132, 0
    v_mov_b32 v133, 0
    v_mov_b32 v134, 0
    v_mov_b32 v135, 0
    v_mov_b32 v136, 0
    v_mov_b32 v137, 0
    v_mov_b32 v138, 0
    v_mov_b32 v139, 0
    v_mov_b32 v140, 0
    v_mov_b32 v141, 0
    v_mov_b32 v142, 0
    v_mov_b32 v143, 0
    v_mov_b32 v144, 0
    v_mov_b32 v145, 0
    v_mov_b32 v146, 0
    v_mov_b32 v147, 0
    v_mov_b32 v148, 0
    v_mov_b32 v149, 0
    v_mov_b32 v150, 0
    v_mov_b32 v151, 0
    v_mov_b32 v152, 0
    v_mov_b32 v153, 0
    v_mov_b32 v154, 0
    v_mov_b32 v155, 0
    v_mov_b32 v156, 0
    v_mov_b32 v157, 0
    v_mov_b32 v158, 0
    v_mov_b32 v159, 0
    v_mov_b32 v160, 0
    v_mov_b32 v161, 0
    v_mov_b32 v162, 0
    v_mov_b32 v163, 0
    v_mov_b32 v164, 0
    v_mov_b32 v165, 0
    v_mov_b32 v166, 0
    v_mov_b32 v167, 0
    v_mov_b32 v168, 0
    v_mov_b32 v169, 0
    v_mov_b32 v170, 0
    v_mov_b32 v171, 0
    v_mov_b32 v172, 0
    v_mov_b32 v173, 0
    v_mov_b32 v174, 0
    v_mov_b32 v175, 0
    v_mov_b32 v176, 0
    v_mov_b32 v177, 0
    v_mov_b32 v178, 0
    v_mov_b32 v179, 0
    v_mov_b32 v180, 0
    v_mov_b32 v181, 0
    v_mov_b32 v182, 0
    v_mov_b32 v183, 0
    v_mov_b32 v184, 0
    v_mov_b32 v185, 0
    v_mov_b32 v186, 0
    v_mov_b32 v187, 0
    v_mov_b32 v188, 0
    v_mov_b32 v189, 0
    v_mov_b32 v190, 0
    v_mov_b32 v191, 0
    v_mov_b32 v192, 0
    v_mov_b32 v193, 0
    v_mov_b32 v194, 0
    v_mov_b32 v195, 0
    v_mov_b32 v196, 0
    v_mov_b32 v197, 0
    v_mov_b32 v198, 0
    v_mov_b32 v199, 0
    v_mov_b32 v200, 0
    v_mov_b32 v201, 0
    v_mov_b32 v202, 0
    v_mov_b32 v203, 0
    v_mov_b32 v204, 0
    v_mov_b32 v205, 0
    v_mov_b32 v206, 0
    v_mov_b32 v207, 0
    v_mov_b32 v208, 0
    v_mov_b32 v209, 0
    v_mov_b32 v210, 0
    v_mov_b32 v211, 0
    v_mov_b32 v212, 0
    v_mov_b32 v213, 0
    v_mov_b32 v214, 0
    v_mov_b32 v215, 0
    v_mov_b32 v216, 0
    v_mov_b32 v217, 0
    v_mov_b32 v218, 0
    v_mov_b32 v219, 0
    v_mov_b32 v220, 0
    v_mov_b32 v221, 0
    v_mov_b32 v222, 0
    v_mov_b32 v223, 0
    v_mov_b32 v224, 0
    v_mov_b32 v225, 0
    v_mov_b32 v226, 0
    v_mov_b32 v227, 0
    v_mov_b32 v228, 0
    v_mov_b32 v229, 0
    v_mov_b32 v230, 0
    v_mov_b32 v231, 0
    v_mov_b32 v232, 0
    v_mov_b32 v233, 0
    v_mov_b32 v234, 0
    v_mov_b32 v235, 0
    v_mov_b32 v236, 0
    v_mov_b32 v237, 0
    v_mov_b32 v238, 0
    v_mov_b32 v239, 0
    v_mov_b32 v240, 0
    v_mov_b32 v241, 0
    v_mov_b32 v242, 0
    v_mov_b32 v243, 0
    v_mov_b32 v244, 0
    v_mov_b32 v245, 0
    v_mov_b32 v246, 0
    v_mov_b32 v247, 0
    v_mov_b32 v248, 0
    v_mov_b32 v249, 0
    v_mov_b32 v250, 0
    v_mov_b32 v251, 0
    v_mov_b32 v252, 0
    v_mov_b32 v253, 0
    v_mov_b32 v254, 0
    v_mov_b32 v255, 0
L_G1:
    v_and_b32 v4, 15, v0
    v_lshrrev_b32 v5, 4, v0
    v_bfe_u32 v21, v0, 1, 3
    v_xor_b32 v21, v21, v5
    v_lshlrev_b32 v21, 4, v21
    v_lshl_add_u32 v21, v4, 7, v21
    s_lshl_b32 s72, s3, 13
    v_add_u32 v8, s72, v21
    v_xor_b32 v9, 64, v8
    v_bfe_u32 v21, v0, 2, 2
    v_and_b32 v22, 3, v0
    v_lshl_add_u32 v4, v5, 3, v21
    v_lshlrev_b32 v4, 7, v4
    v_lshl_add_u32 v4, v22, 3, v4
    v_add_u32 v4, 98304, v4
    v_and_b32 v5, 1, v5
    v_lshrrev_b32 v21, 1, v21
    v_lshl_or_b32 v21, v5, 1, v21
    v_xor_b32 v22, 0, v21
    v_lshl_add_u32 v12, v22, 5, v4
    v_xor_b32 v22, 1, v21
    v_lshl_add_u32 v13, v22, 5, v4
    v_xor_b32 v22, 2, v21
    v_lshl_add_u32 v14, v22, 5, v4
    v_xor_b32 v22, 3, v21
    v_lshl_add_u32 v15, v22, 5, v4
    s_lshl_b32 s72, s3, 2
    v_mov_b32 v19, 163072
    s_mov_b32 s4, 1
    s_mov_b32 s7, 0
    s_add_u32 m0, s72, 163088
    v_mov_b32 v4, 163076
    s_mov_b32 s73, 200000
LW_5:
    ds_read_b32 v16, v4
    s_waitcnt lgkmcnt(0)
    v_readfirstlane_b32 s72, v16
    s_nop 1
    s_cmp_ge_u32 s72, 1
    s_cbranch_scc1 LWD_6
    s_sub_u32 s73, s73, 1
    s_cmp_eq_u32 s73, 0
    s_cbranch_scc1 LWD_6
    s_sleep 1
    s_branch LW_5
LWD_6:
    s_setprio 3
    ds_read_b128 v[64:67], v8 offset:0
    ds_read_b128 v[68:71], v8 offset:2048
    ds_read_b128 v[72:75], v8 offset:4096
    ds_read_b128 v[76:79], v8 offset:6144
    ds_read_b64_tr_b16 v[32:33], v12 offset:0
    ds_read_b64_tr_b16 v[34:35], v12 offset:512
    ds_read_b64_tr_b16 v[36:37], v13 offset:0
    ds_read_b64_tr_b16 v[38:39], v13 offset:512
    ds_read_b64_tr_b16 v[40:41], v14 offset:0
    ds_read_b64_tr_b16 v[42:43], v14 offset:512
    ds_read_b64_tr_b16 v[44:45], v15 offset:0
    ds_read_b64_tr_b16 v[46:47], v15 offset:512
    ds_read_b64_tr_b16 v[48:49], v12 offset:8192
    ds_read_b64_tr_b16 v[50:51], v12 offset:8704
    ds_read_b64_tr_b16 v[52:53], v13 offset:8192
    ds_read_b64_tr_b16 v[54:55], v13 offset:8704
    ds_read_b64_tr_b16 v[56:57], v14 offset:8192
    ds_read_b64_tr_b16 v[58:59], v14 offset:8704
    ds_read_b128 v[80:83], v9 offset:0
    ds_read_b128 v[84:87], v9 offset:2048
    ds_read_b128 v[88:91], v9 offset:4096
    ds_read_b128 v[92:95], v9 offset:6144
    v_add_u32 v8, 0x8000, v8
    v_add_u32 v9, 0x8000, v9
    s_getpc_b64 s[56:57]
L_TBREF:
    s_add_u32 s56, s56, L_TABLE-L_TBREF
    s_addc_u32 s57, s57, 0
    s_mov_b32 s58, 384
    s_mov_b32 s59, 0x00020000
    v_mov_b32 v20, 0
    s_mov_b32 s9, 16384
    s_mov_b32 s10, -32768
    s_mov_b32 s11, 32768
    s_mov_b32 s12, -65536
    s_mov_b32 s98, 0
    s_mov_b32 s99, 0
    s_and_b32 s72, s2, 7
    s_lshr_b32 s73, s2, 3
    s_lshl_b32 s84, s72, 2
    s_and_b32 s74, s73, 3
    s_add_u32 s84, s84, s74
    s_lshr_b32 s85, s73, 2
    s_sub_u32 s73, s3, 1
    s_mul_i32 s73, s73, 14
    s_add_u32 s73, s73, 12
    s_cmp_eq_u32 s3, 0
    s_cselect_b32 s73, 0, s73
    s_cselect_b32 s87, 12, 14
    s_mov_b32 s74, 0
    s_lshr_b32 s86, s87, 1
    s_sub_u32 s75, 3, s87
    s_lshl_b32 s89, s75, 12
    s_mul_i32 s90, s75, 5120
    s_mul_i32 s72, s84, 54
    s_add_u32 s72, s72, s73
    s_add_u32 s72, s72, s74
    s_lshl_b32 s81, s72, 12
    s_mul_i32 s72, s85, 54
    s_add_u32 s72, s72, s73
    s_mul_i32 s88, s72, 5120
    s_add_u32 s88, s88, 12582912
    s_mul_i32 s74, s74, 5120
    s_add_u32 s82, s88, s74
    s_mov_b32 s75, 131072
    s_cmp_eq_u32 s3, 1
    s_cselect_b32 s75, 0, s75
    s_cmp_eq_u32 s3, 2
    s_cselect_b32 s75, 65536, s75
    s_cmp_eq_u32 s3, 3
    s_cselect_b32 s75, 86016, s75
    v_lshlrev_b32 v24, 4, v0
    v_add_u32 v26, 1024, v24
    v_add_u32 v27, s75, v24
    s_lshl_b32 s72, s84, 2
    s_add_u32 s72, s72, s3
    s_mul_i32 s83, s72, 20480
    s_mul_i32 s72, s85, 160
    s_add_u32 s83, s83, s72
    s_lshl_b32 s76, s68, 2
    s_add_u32 s76, s76, s3
    s_mul_i32 s77, s76, 221184
    s_lshl_b32 s78, s69, 13
    s_add_u32 s77, s77, s78
    s_lshl_b32 s72, s76, 9
    s_and_b32 s73, s69, 7
    s_lshl_b32 s73, s73, 2
    s_add_u32 s72, s72, s73
    s_lshr_b32 s73, s69, 3
    s_lshl_b32 s73, s73, 7
    s_add_u32 s72, s72, s73
    s_add_u32 s79, s72, 21233664
    v_lshrrev_b32 v25, 4, v0
    v_lshlrev_b32 v25, 4, v25
    v_add_u32 v25, 160512, v25
    v_and_b32 v28, 15, v0
    v_lshlrev_b32 v28, 3, v28
    s_lshl_b32 s72, s3, 9
    s_add_u32 s72, s72, 161024
    v_add_u32 v28, s72, v28
    s_lshl_b32 s72, s3, 2
    v_mov_b32 v29, 163216
    v_add_u32 v29, s72, v29
    s_waitcnt lgkmcnt(0)
L_G1LOOP:
    s_waitcnt lgkmcnt(12)
    v_mfma_f32_16x16x32_bf16 v[128:131], v[32:35], v[64:67], v[128:131]
    ds_read_b64_tr_b16 v[60:61], v15 offset:8192
    v_mfma_f32_16x16x32_bf16 v[132:135], v[32:35], v[68:71], v[132:135]
    ds_read_b64_tr_b16 v[62:63], v15 offset:8704
    v_mfma_f32_16x16x32_bf16 v[136:139], v[32:35], v[72:75], v[136:139]
    s_lshl_b32 s13, s4, 5
    v_mfma_f32_16x16x32_bf16 v[140:143], v[32:35], v[76:79], v[140:143]
    s_cmp_eq_u32 s7, 2
    s_cselect_b32 s6, s10, s9
    v_mfma_f32_16x16x32_bf16 v[144:147], v[36:39], v[64:67], v[144:147]
    ds_read_b64_tr_b16 v[32:33], v12 offset:4096
    v_mfma_f32_16x16x32_bf16 v[148:151], v[36:39], v[68:71], v[148:151]
    ds_read_b64_tr_b16 v[34:35], v12 offset:4608
    v_mfma_f32_16x16x32_bf16 v[152:155], v[36:39], v[72:75], v[152:155]
    v_mfma_f32_16x16x32_bf16 v[156:159], v[36:39], v[76:79], v[156:159]
    s_cmp_eq_u32 s7, 1
    s_cselect_b32 s5, s12, s11
    v_mfma_f32_16x16x32_bf16 v[160:163], v[40:43], v[64:67], v[160:163]
    ds_read_b64_tr_b16 v[36:37], v13 offset:4096
    v_mfma_f32_16x16x32_bf16 v[164:167], v[40:43], v[68:71], v[164:167]
    ds_read_b64_tr_b16 v[38:39], v13 offset:4608
    v_mfma_f32_16x16x32_bf16 v[168:171], v[40:43], v[72:75], v[168:171]
    v_mfma_f32_16x16x32_bf16 v[172:175], v[40:43], v[76:79], v[172:175]
    s_add_u32 s7, s7, 1
    s_waitcnt lgkmcnt(15)
    v_mfma_f32_16x16x32_bf16 v[176:179], v[44:47], v[64:67], v[176:179]
    ds_read_b64_tr_b16 v[40:41], v14 offset:4096
    v_mfma_f32_16x16x32_bf16 v[180:183], v[44:47], v[68:71], v[180:183]
    ds_read_b64_tr_b16 v[42:43], v14 offset:4608
    v_mfma_f32_16x16x32_bf16 v[184:187], v[44:47], v[72:75], v[184:187]
    ds_read_b64 v[16:17], v19
    v_mfma_f32_16x16x32_bf16 v[188:191], v[44:47], v[76:79], v[188:191]
    s_cmp_eq_u32 s7, 3
    s_cselect_b32 s7, 0, s7
    s_waitcnt lgkmcnt(15)
    v_mfma_f32_16x16x32_bf16 v[192:195], v[48:51], v[64:67], v[192:195]
    ds_read_b64_tr_b16 v[44:45], v15 offset:4096
    v_mfma_f32_16x16x32_bf16 v[196:199], v[48:51], v[68:71], v[196:199]
    ds_read_b64_tr_b16 v[46:47], v15 offset:4608
    v_mfma_f32_16x16x32_bf16 v[200:203], v[48:51], v[72:75], v[200:203]
    s_waitcnt lgkmcnt(11)
    s_mov_b64 exec, 1
    buffer_load_dword v20, s[56:59], s13 offen offset:0 lds
    s_mov_b64 exec, -1
    v_mfma_f32_16x16x32_bf16 v[204:207], v[48:51], v[76:79], v[204:207]
    s_add_u32 s8, s4, 1
    v_mfma_f32_16x16x32_bf16 v[208:211], v[52:55], v[64:67], v[208:211]
    ds_read_b64_tr_b16 v[48:49], v12 offset:12288
    v_mfma_f32_16x16x32_bf16 v[212:215], v[52:55], v[68:71], v[212:215]
    ds_read_b64_tr_b16 v[50:51], v12 offset:12800
    v_mfma_f32_16x16x32_bf16 v[216:219], v[52:55], v[72:75], v[216:219]
    v_mfma_f32_16x16x32_bf16 v[220:223], v[52:55], v[76:79], v[220:223]
    v_mfma_f32_16x16x32_bf16 v[224:227], v[56:59], v[64:67], v[224:227]
    ds_read_b64_tr_b16 v[52:53], v13 offset:12288
    v_mfma_f32_16x16x32_bf16 v[228:231], v[56:59], v[68:71], v[228:231]
    ds_read_b64_tr_b16 v[54:55], v13 offset:12800
    v_mfma_f32_16x16x32_bf16 v[232:235], v[56:59], v[72:75], v[232:235]
    s_waitcnt lgkmcnt(6)
    v_min_u32 v16, v16, v17
    v_mfma_f32_16x16x32_bf16 v[236:239], v[56:59], v[76:79], v[236:239]
    v_mfma_f32_16x16x32_bf16 v[240:243], v[60:63], v[64:67], v[240:243]
    ds_read_b64_tr_b16 v[56:57], v14 offset:12288
    v_mfma_f32_16x16x32_bf16 v[244:247], v[60:63], v[68:71], v[244:247]
    ds_read_b64_tr_b16 v[58:59], v14 offset:12800
    v_mfma_f32_16x16x32_bf16 v[248:251], v[60:63], v[72:75], v[248:251]
    v_readfirstlane_b32 s72, v16
    v_mfma_f32_16x16x32_bf16 v[252:255], v[60:63], v[76:79], v[252:255]
    s_nop 0
    s_cmp_ge_u32 s72, s8
    s_cbranch_scc0 L_G1SLOW0
L_G1OK0:
    v_mfma_f32_16x16x32_bf16 v[128:131], v[32:35], v[80:83], v[128:131]
    ds_read_b64_tr_b16 v[60:61], v15 offset:12288
    v_mfma_f32_16x16x32_bf16 v[132:135], v[32:35], v[84:87], v[132:135]
    ds_read_b64_tr_b16 v[62:63], v15 offset:12800
    v_mfma_f32_16x16x32_bf16 v[136:139], v[32:35], v[88:91], v[136:139]
    v_add_u32 v12, s6, v12
    v_add_u32 v13, s6, v13
    ds_read_b128 v[96:99], v8 offset:0
    v_mfma_f32_16x16x32_bf16 v[140:143], v[32:35], v[92:95], v[140:143]
    v_add_u32 v14, s6, v14
    v_add_u32 v15, s6, v15
    v_mfma_f32_16x16x32_bf16 v[144:147], v[36:39], v[80:83], v[144:147]
    ds_read_b64_tr_b16 v[32:33], v12 offset:0
    v_mfma_f32_16x16x32_bf16 v[148:151], v[36:39], v[84:87], v[148:151]
    ds_read_b64_tr_b16 v[34:35], v12 offset:512
    v_mfma_f32_16x16x32_bf16 v[152:155], v[36:39], v[88:91], v[152:155]
    ds_read_b128 v[100:103], v8 offset:2048
    v_mfma_f32_16x16x32_bf16 v[156:159], v[36:39], v[92:95], v[156:159]
    v_mfma_f32_16x16x32_bf16 v[160:163], v[40:43], v[80:83], v[160:163]
    ds_read_b64_tr_b16 v[36:37], v13 offset:0
    v_mfma_f32_16x16x32_bf16 v[164:167], v[40:43], v[84:87], v[164:167]
    ds_read_b64_tr_b16 v[38:39], v13 offset:512
    v_mfma_f32_16x16x32_bf16 v[168:171], v[40:43], v[88:91], v[168:171]
    ds_read_b128 v[104:107], v8 offset:4096
    v_mfma_f32_16x16x32_bf16 v[172:175], v[40:43], v[92:95], v[172:175]
    s_waitcnt lgkmcnt(15)
    v_mfma_f32_16x16x32_bf16 v[176:179], v[44:47], v[80:83], v[176:179]
    ds_read_b64_tr_b16 v[40:41], v14 offset:0
    v_mfma_f32_16x16x32_bf16 v[180:183], v[44:47], v[84:87], v[180:183]
    ds_read_b64_tr_b16 v[42:43], v14 offset:512
    v_mfma_f32_16x16x32_bf16 v[184:187], v[44:47], v[88:91], v[184:187]
    ds_read_b128 v[108:111], v8 offset:6144
    v_mfma_f32_16x16x32_bf16 v[188:191], v[44:47], v[92:95], v[188:191]
    v_add_u32 v8, s5, v8
    s_waitcnt lgkmcnt(15)
    v_mfma_f32_16x16x32_bf16 v[192:195], v[48:51], v[80:83], v[192:195]
    ds_read_b64_tr_b16 v[44:45], v15 offset:0
    v_mfma_f32_16x16x32_bf16 v[196:199], v[48:51], v[84:87], v[196:199]
    ds_read_b64_tr_b16 v[46:47], v15 offset:512
    v_mfma_f32_16x16x32_bf16 v[200:203], v[48:51], v[88:91], v[200:203]
    ds_read_b128 v[112:115], v9 offset:0
    v_mfma_f32_16x16x32_bf16 v[204:207], v[48:51], v[92:95], v[204:207]
    s_waitcnt lgkmcnt(15)
    v_mfma_f32_16x16x32_bf16 v[208:211], v[52:55], v[80:83], v[208:211]
    ds_read_b64_tr_b16 v[48:49], v12 offset:8192
    v_mfma_f32_16x16x32_bf16 v[212:215], v[52:55], v[84:87], v[212:215]
    ds_read_b64_tr_b16 v[50:51], v12 offset:8704
    v_mfma_f32_16x16x32_bf16 v[216:219], v[52:55], v[88:91], v[216:219]
    ds_read_b128 v[116:119], v9 offset:2048
    v_mfma_f32_16x16x32_bf16 v[220:223], v[52:55], v[92:95], v[220:223]
    s_waitcnt lgkmcnt(15)
    v_mfma_f32_16x16x32_bf16 v[224:227], v[56:59], v[80:83], v[224:227]
    ds_read_b64_tr_b16 v[52:53], v13 offset:8192
    v_mfma_f32_16x16x32_bf16 v[228:231], v[56:59], v[84:87], v[228:231]
    ds_read_b64_tr_b16 v[54:55], v13 offset:8704
    v_mfma_f32_16x16x32_bf16 v[232:235], v[56:59], v[88:91], v[232:235]
    ds_read_b128 v[120:123], v9 offset:4096
    v_mfma_f32_16x16x32_bf16 v[236:239], v[56:59], v[92:95], v[236:239]
    s_add_u32 s4, s4, 1
    s_waitcnt lgkmcnt(15)
    v_mfma_f32_16x16x32_bf16 v[240:243], v[60:63], v[80:83], v[240:243]
    ds_read_b64_tr_b16 v[56:57], v14 offset:8192
    v_mfma_f32_16x16x32_bf16 v[244:247], v[60:63], v[84:87], v[244:247]
    ds_read_b64_tr_b16 v[58:59], v14 offset:8704
    v_mfma_f32_16x16x32_bf16 v[248:251], v[60:63], v[88:91], v[248:251]
    ds_read_b128 v[124:127], v9 offset:6144
    v_mfma_f32_16x16x32_bf16 v[252:255], v[60:63], v[92:95], v[252:255]
    v_add_u32 v9, s5, v9
    s_mov_b64 exec, 1
    buffer_load_dword v20, s[56:59], s13 offen offset:16 lds
    s_mov_b64 exec, -1
    s_waitcnt lgkmcnt(12)
    v_mfma_f32_16x16x32_bf16 v[128:131], v[32:35], v[96:99], v[128:131]
    ds_read_b64_tr_b16 v[60:61], v15 offset:8192
    v_mfma_f32_16x16x32_bf16 v[132:135], v[32:35], v[100:103], v[132:135]
    ds_read_b64_tr_b16 v[62:63], v15 offset:8704
    v_mfma_f32_16x16x32_bf16 v[136:139], v[32:35], v[104:107], v[136:139]
    s_lshl_b32 s13, s4, 5
    v_mfma_f32_16x16x32_bf16 v[140:143], v[32:35], v[108:111], v[140:143]
    s_cmp_eq_u32 s7, 2
    s_cselect_b32 s6, s10, s9
    v_mfma_f32_16x16x32_bf16 v[144:147], v[36:39], v[96:99], v[144:147]
    ds_read_b64_tr_b16 v[32:33], v12 offset:4096
    v_mfma_f32_16x16x32_bf16 v[148:151], v[36:39], v[100:103], v[148:151]
    ds_read_b64_tr_b16 v[34:35], v12 offset:4608
    v_mfma_f32_16x16x32_bf16 v[152:155], v[36:39], v[104:107], v[152:155]
    v_mfma_f32_16x16x32_bf16 v[156:159], v[36:39], v[108:111], v[156:159]
    s_cmp_eq_u32 s7, 1
    s_cselect_b32 s5, s12, s11
    v_mfma_f32_16x16x32_bf16 v[160:163], v[40:43], v[96:99], v[160:163]
    ds_read_b64_tr_b16 v[36:37], v13 offset:4096
    v_mfma_f32_16x16x32_bf16 v[164:167], v[40:43], v[100:103], v[164:167]
    ds_read_b64_tr_b16 v[38:39], v13 offset:4608
    v_mfma_f32_16x16x32_bf16 v[168:171], v[40:43], v[104:107], v[168:171]
    v_mfma_f32_16x16x32_bf16 v[172:175], v[40:43], v[108:111], v[172:175]
    s_add_u32 s7, s7, 1
    s_waitcnt lgkmcnt(15)
    v_mfma_f32_16x16x32_bf16 v[176:179], v[44:47], v[96:99], v[176:179]
    ds_read_b64_tr_b16 v[40:41], v14 offset:4096
    v_mfma_f32_16x16x32_bf16 v[180:183], v[44:47], v[100:103], v[180:183]
    ds_read_b64_tr_b16 v[42:43], v14 offset:4608
    v_mfma_f32_16x16x32_bf16 v[184:187], v[44:47], v[104:107], v[184:187]
    ds_read_b64 v[16:17], v19
    v_mfma_f32_16x16x32_bf16 v[188:191], v[44:47], v[108:111], v[188:191]
    s_cmp_eq_u32 s7, 3
    s_cselect_b32 s7, 0, s7
    s_waitcnt lgkmcnt(15)
    v_mfma_f32_16x16x32_bf16 v[192:195], v[48:51], v[96:99], v[192:195]
    ds_read_b64_tr_b16 v[44:45], v15 offset:4096
    v_mfma_f32_16x16x32_bf16 v[196:199], v[48:51], v[100:103], v[196:199]
    ds_read_b64_tr_b16 v[46:47], v15 offset:4608
    v_mfma_f32_16x16x32_bf16 v[200:203], v[48:51], v[104:107], v[200:203]
    s_waitcnt lgkmcnt(11)
    s_mov_b64 exec, 1
    buffer_load_dword v20, s[56:59], s13 offen offset:0 lds
    s_mov_b64 exec, -1
    v_mfma_f32_16x16x32_bf16 v[204:207], v[48:51], v[108:111], v[204:207]
    s_add_u32 s8, s4, 1
    v_mfma_f32_16x16x32_bf16 v[208:211], v[52:55], v[96:99], v[208:211]
    ds_read_b64_tr_b16 v[48:49], v12 offset:12288
    v_mfma_f32_16x16x32_bf16 v[212:215], v[52:55], v[100:103], v[212:215]
    ds_read_b64_tr_b16 v[50:51], v12 offset:12800
    v_mfma_f32_16x16x32_bf16 v[216:219], v[52:55], v[104:107], v[216:219]
    v_mfma_f32_16x16x32_bf16 v[220:223], v[52:55], v[108:111], v[220:223]
    v_mfma_f32_16x16x32_bf16 v[224:227], v[56:59], v[96:99], v[224:227]
    ds_read_b64_tr_b16 v[52:53], v13 offset:12288
    v_mfma_f32_16x16x32_bf16 v[228:231], v[56:59], v[100:103], v[228:231]
    ds_read_b64_tr_b16 v[54:55], v13 offset:12800
    v_mfma_f32_16x16x32_bf16 v[232:235], v[56:59], v[104:107], v[232:235]
    s_waitcnt lgkmcnt(6)
    v_min_u32 v16, v16, v17
    v_mfma_f32_16x16x32_bf16 v[236:239], v[56:59], v[108:111], v[236:239]
    v_mfma_f32_16x16x32_bf16 v[240:243], v[60:63], v[96:99], v[240:243]
    ds_read_b64_tr_b16 v[56:57], v14 offset:12288
    v_mfma_f32_16x16x32_bf16 v[244:247], v[60:63], v[100:103], v[244:247]
    ds_read_b64_tr_b16 v[58:59], v14 offset:12800
    v_mfma_f32_16x16x32_bf16 v[248:251], v[60:63], v[104:107], v[248:251]
    v_readfirstlane_b32 s72, v16
    v_mfma_f32_16x16x32_bf16 v[252:255], v[60:63], v[108:111], v[252:255]
    s_nop 0
    s_cmp_ge_u32 s72, s8
    s_cbranch_scc0 L_G1SLOW1
L_G1OK1:
    v_mfma_f32_16x16x32_bf16 v[128:131], v[32:35], v[112:115], v[128:131]
    ds_read_b64_tr_b16 v[60:61], v15 offset:12288
    v_mfma_f32_16x16x32_bf16 v[132:135], v[32:35], v[116:119], v[132:135]
    ds_read_b64_tr_b16 v[62:63], v15 offset:12800
    v_mfma_f32_16x16x32_bf16 v[136:139], v[32:35], v[120:123], v[136:139]
    v_add_u32 v12, s6, v12
    v_add_u32 v13, s6, v13
    ds_read_b128 v[64:67], v8 offset:0
    v_mfma_f32_16x16x32_bf16 v[140:143], v[32:35], v[124:127], v[140:143]
    v_add_u32 v14, s6, v14
    v_add_u32 v15, s6, v15
    v_mfma_f32_16x16x32_bf16 v[144:147], v[36:39], v[112:115], v[144:147]
    ds_read_b64_tr_b16 v[32:33], v12 offset:0
    v_mfma_f32_16x16x32_bf16 v[148:151], v[36:39], v[116:119], v[148:151]
    ds_read_b64_tr_b16 v[34:35], v12 offset:512
    v_mfma_f32_16x16x32_bf16 v[152:155], v[36:39], v[120:123], v[152:155]
    ds_read_b128 v[68:71], v8 offset:2048
    v_mfma_f32_16x16x32_bf16 v[156:159], v[36:39], v[124:127], v[156:159]
    v_mfma_f32_16x16x32_bf16 v[160:163], v[40:43], v[112:115], v[160:163]
    ds_read_b64_tr_b16 v[36:37], v13 offset:0
    v_mfma_f32_16x16x32_bf16 v[164:167], v[40:43], v[116:119], v[164:167]
    ds_read_b64_tr_b16 v[38:39], v13 offset:512
    v_mfma_f32_16x16x32_bf16 v[168:171], v[40:43], v[120:123], v[168:171]
    ds_read_b128 v[72:75], v8 offset:4096
    v_mfma_f32_16x16x32_bf16 v[172:175], v[40:43], v[124:127], v[172:175]
    s_waitcnt lgkmcnt(15)
    v_mfma_f32_16x16x32_bf16 v[176:179], v[44:47], v[112:115], v[176:179]
    ds_read_b64_tr_b16 v[40:41], v14 offset:0
    v_mfma_f32_16x16x32_bf16 v[180:183], v[44:47], v[116:119], v[180:183]
    ds_read_b64_tr_b16 v[42:43], v14 offset:512
    v_mfma_f32_16x16x32_bf16 v[184:187], v[44:47], v[120:123], v[184:187]
    ds_read_b128 v[76:79], v8 offset:6144
    v_mfma_f32_16x16x32_bf16 v[188:191], v[44:47], v[124:127], v[188:191]
    v_add_u32 v8, s5, v8
    s_waitcnt lgkmcnt(15)
    v_mfma_f32_16x16x32_bf16 v[192:195], v[48:51], v[112:115], v[192:195]
    ds_read_b64_tr_b16 v[44:45], v15 offset:0
    v_mfma_f32_16x16x32_bf16 v[196:199], v[48:51], v[116:119], v[196:199]
    ds_read_b64_tr_b16 v[46:47], v15 offset:512
    v_mfma_f32_16x16x32_bf16 v[200:203], v[48:51], v[120:123], v[200:203]
    ds_read_b128 v[80:83], v9 offset:0
    v_mfma_f32_16x16x32_bf16 v[204:207], v[48:51], v[124:127], v[204:207]
    s_waitcnt lgkmcnt(15)
    v_mfma_f32_16x16x32_bf16 v[208:211], v[52:55], v[112:115], v[208:211]
    ds_read_b64_tr_b16 v[48:49], v12 offset:8192
    v_mfma_f32_16x16x32_bf16 v[212:215], v[52:55], v[116:119], v[212:215]
    ds_read_b64_tr_b16 v[50:51], v12 offset:8704
    v_mfma_f32_16x16x32_bf16 v[216:219], v[52:55], v[120:123], v[216:219]
    ds_read_b128 v[84:87], v9 offset:2048
    v_mfma_f32_16x16x32_bf16 v[220:223], v[52:55], v[124:127], v[220:223]
    s_waitcnt lgkmcnt(15)
    v_mfma_f32_16x16x32_bf16 v[224:227], v[56:59], v[112:115], v[224:227]
    ds_read_b64_tr_b16 v[52:53], v13 offset:8192
    v_mfma_f32_16x16x32_bf16 v[228:231], v[56:59], v[116:119], v[228:231]
    ds_read_b64_tr_b16 v[54:55], v13 offset:8704
    v_mfma_f32_16x16x32_bf16 v[232:235], v[56:59], v[120:123], v[232:235]
    ds_read_b128 v[88:91], v9 offset:4096
    v_mfma_f32_16x16x32_bf16 v[236:239], v[56:59], v[124:127], v[236:239]
    s_add_u32 s4, s4, 1
    s_waitcnt lgkmcnt(15)
    v_mfma_f32_16x16x32_bf16 v[240:243], v[60:63], v[112:115], v[240:243]
    ds_read_b64_tr_b16 v[56:57], v14 offset:8192
    v_mfma_f32_16x16x32_bf16 v[244:247], v[60:63], v[116:119], v[244:247]
    ds_read_b64_tr_b16 v[58:59], v14 offset:8704
    s_cmp_le_u32 s4, 10
    v_mfma_f32_16x16x32_bf16 v[248:251], v[60:63], v[120:123], v[248:251]
    ds_read_b128 v[92:95], v9 offset:6144
    v_mfma_f32_16x16x32_bf16 v[252:255], v[60:63], v[124:127], v[252:255]
    v_add_u32 v9, s5, v9
    s_mov_b64 exec, 1
    buffer_load_dword v20, s[56:59], s13 offen offset:16 lds
    s_mov_b64 exec, -1
    s_cbranch_scc1 L_G1LOOP
    s_branch L_G1EPI
L_G1SLOW0:
    v_mov_b32 v4, 163072
    s_mov_b32 s73, 200000
LW_7:
    ds_read_b64 v[22:23], v4
    s_waitcnt lgkmcnt(0)
    v_min_u32 v22, v22, v23
    s_nop 0
    v_readfirstlane_b32 s72, v22
    s_nop 1
    s_cmp_ge_u32 s72, s8
    s_cbranch_scc1 LWD_8
    s_sub_u32 s73, s73, 1
    s_cmp_eq_u32 s73, 0
    s_cbranch_scc1 LWD_8
    s_sleep 0
    s_branch LW_7
LWD_8:
    s_branch L_G1OK0
L_G1SLOW1:
    v_mov_b32 v4, 163072
    s_mov_b32 s73, 200000
LW_9:
    ds_read_b64 v[22:23], v4
    s_waitcnt lgkmcnt(0)
    v_min_u32 v22, v22, v23
    s_nop 0
    v_readfirstlane_b32 s72, v22
    s_nop 1
    s_cmp_ge_u32 s72, s8
    s_cbranch_scc1 LWD_10
    s_sub_u32 s73, s73, 1
    s_cmp_eq_u32 s73, 0
    s_cbranch_scc1 LWD_10
    s_sleep 0
    s_branch LW_9
LWD_10:
    s_branch L_G1OK1
L_G1EPI:
    v_mov_b32 v4, 163152
    s_mov_b32 s73, 200000
LW_11:
    ds_read_b32 v20, v4
    s_waitcnt lgkmcnt(0)
    v_readfirstlane_b32 s72, v20
    s_nop 1
    s_cmp_ge_u32 s72, 1
    s_cbranch_scc1 LWD_12
    s_sub_u32 s73, s73, 1
    s_cmp_eq_u32 s73, 0
    s_cbranch_scc1 LWD_12
    s_sleep 1
    s_branch LW_11
LWD_12:
    ds_read_b64 v[8:9], v28 offset:0
    ds_read_b64 v[12:13], v28 offset:128
    ds_read_b64 v[16:17], v28 offset:256
    ds_read_b64 v[20:21], v28 offset:384
    ds_read_b128 v[32:35], v25 offset:0
    ds_read_b128 v[36:39], v25 offset:64
    ds_read_b128 v[40:43], v25 offset:256
    ds_read_b128 v[44:47], v25 offset:320
    ds_read_b128 v[48:51], v25 offset:128
    ds_read_b128 v[52:55], v25 offset:192
    ds_read_b128 v[56:59], v25 offset:384
    ds_read_b128 v[60:63], v25 offset:448
    s_waitcnt lgkmcnt(8)
    v_rcp_f32 v10, v9
    v_mul_f32 v9, v9, v9
    v_mul_f32 v11, v10, v10
    v_mul_f32 v11, v11, v10
    v_mul_f32 v10, 0xc0135761, v10
    v_mul_f32 v11, 0xbdd2d3e8, v11
    v_rcp_f32 v14, v13
    v_mul_f32 v13, v13, v13
    v_mul_f32 v15, v14, v14
    v_mul_f32 v15, v15, v14
    v_mul_f32 v14, 0xc0135761, v14
    v_mul_f32 v15, 0xbdd2d3e8, v15
    v_rcp_f32 v18, v17
    v_mul_f32 v17, v17, v17
    v_mul_f32 v19, v18, v18
    v_mul_f32 v19, v19, v18
    v_mul_f32 v18, 0xc0135761, v18
    v_mul_f32 v19, 0xbdd2d3e8, v19
    v_rcp_f32 v22, v21
    v_mul_f32 v21, v21, v21
    v_mul_f32 v23, v22, v22
    v_mul_f32 v23, v23, v22
    v_mul_f32 v22, 0xc0135761, v22
    v_mul_f32 v23, 0xbdd2d3e8, v23
    s_waitcnt lgkmcnt(0)
    v_pk_fma_f32 v[128:129], v[8:9], v[32:33], v[128:129] op_sel_hi:[0,1,1] neg_lo:[1,0,0] neg_hi:[1,0,0]
    v_pk_fma_f32 v[130:131], v[8:9], v[34:35], v[130:131] op_sel_hi:[0,1,1] neg_lo:[1,0,0] neg_hi:[1,0,0]
    v_pk_fma_f32 v[144:145], v[8:9], v[36:37], v[144:145] op_sel_hi:[0,1,1] neg_lo:[1,0,0] neg_hi:[1,0,0]
    v_pk_fma_f32 v[146:147], v[8:9], v[38:39], v[146:147] op_sel_hi:[0,1,1] neg_lo:[1,0,0] neg_hi:[1,0,0]
    v_pk_mul_f32 v[64:65], v[128:129], v[128:129]
    v_pk_mul_f32 v[66:67], v[130:131], v[130:131]
    v_pk_mul_f32 v[68:69], v[144:145], v[144:145]
    v_pk_mul_f32 v[70:71], v[146:147], v[146:147]
    v_pk_fma_f32 v[64:65], v[64:65], v[10:11], v[10:11] op_sel:[0,1,0] op_sel_hi:[1,1,0]
    v_pk_fma_f32 v[66:67], v[66:67], v[10:11], v[10:11] op_sel:[0,1,0] op_sel_hi:[1,1,0]
    v_pk_fma_f32 v[68:69], v[68:69], v[10:11], v[10:11] op_sel:[0,1,0] op_sel_hi:[1,1,0]
    v_pk_fma_f32 v[70:71], v[70:71], v[10:11], v[10:11] op_sel:[0,1,0] op_sel_hi:[1,1,0]
    v_pk_mul_f32 v[64:65], v[64:65], v[128:129]
    v_pk_mul_f32 v[66:67], v[66:67], v[130:131]
    v_pk_mul_f32 v[68:69], v[68:69], v[144:145]
    v_pk_mul_f32 v[70:71], v[70:71], v[146:147]
    v_exp_f32 v64, v64
    v_pk_fma_f32 v[192:193], v[8:9], v[40:41], v[192:193] op_sel_hi:[0,1,1] neg_lo:[1,0,0] neg_hi:[1,0,0]
    v_exp_f32 v65, v65
    v_exp_f32 v66, v66
    v_pk_fma_f32 v[194:195], v[8:9], v[42:43], v[194:195] op_sel_hi:[0,1,1] neg_lo:[1,0,0] neg_hi:[1,0,0]
    v_exp_f32 v67, v67
    v_exp_f32 v68, v68
    v_pk_fma_f32 v[208:209], v[8:9], v[44:45], v[208:209] op_sel_hi:[0,1,1] neg_lo:[1,0,0] neg_hi:[1,0,0]
    v_exp_f32 v69, v69
    v_exp_f32 v70, v70
    v_pk_fma_f32 v[210:211], v[8:9], v[46:47], v[210:211] op_sel_hi:[0,1,1] neg_lo:[1,0,0] neg_hi:[1,0,0]
    v_exp_f32 v71, v71
    v_pk_fma_f32 v[64:65], v[64:65], v[8:9], v[8:9] op_sel:[0,1,1] op_sel_hi:[1,1,1]
    v_pk_fma_f32 v[66:67], v[66:67], v[8:9], v[8:9] op_sel:[0,1,1] op_sel_hi:[1,1,1]
    v_pk_fma_f32 v[68:69], v[68:69], v[8:9], v[8:9] op_sel:[0,1,1] op_sel_hi:[1,1,1]
    v_pk_fma_f32 v[70:71], v[70:71], v[8:9], v[8:9] op_sel:[0,1,1] op_sel_hi:[1,1,1]
    v_rcp_f32 v64, v64
    v_pk_mul_f32 v[128:129], v[128:129], v[192:193]
    v_rcp_f32 v65, v65
    v_rcp_f32 v66, v66
    v_pk_mul_f32 v[130:131], v[130:131], v[194:195]
    v_rcp_f32 v67, v67
    v_rcp_f32 v68, v68
    v_pk_mul_f32 v[144:145], v[144:145], v[208:209]
    v_rcp_f32 v69, v69
    v_rcp_f32 v70, v70
    v_pk_mul_f32 v[146:147], v[146:147], v[210:211]
    v_rcp_f32 v71, v71
    v_pk_mul_f32 v[128:129], v[128:129], v[64:65]
    v_pk_mul_f32 v[130:131], v[130:131], v[66:67]
    v_pk_mul_f32 v[144:145], v[144:145], v[68:69]
    v_pk_mul_f32 v[146:147], v[146:147], v[70:71]
    v_cvt_pk_bf16_f32 v72, v128, v129
    v_cvt_pk_bf16_f32 v73, v130, v131
    v_cvt_pk_bf16_f32 v74, v144, v145
    v_cvt_pk_bf16_f32 v75, v146, v147
    buffer_store_dwordx4 v[72:75], v24, s[44:47], s77 offen offset:0 sc1
    v_pk_fma_f32 v[132:133], v[12:13], v[32:33], v[132:133] op_sel_hi:[0,1,1] neg_lo:[1,0,0] neg_hi:[1,0,0]
    v_pk_fma_f32 v[134:135], v[12:13], v[34:35], v[134:135] op_sel_hi:[0,1,1] neg_lo:[1,0,0] neg_hi:[1,0,0]
    v_pk_fma_f32 v[148:149], v[12:13], v[36:37], v[148:149] op_sel_hi:[0,1,1] neg_lo:[1,0,0] neg_hi:[1,0,0]
    v_pk_fma_f32 v[150:151], v[12:13], v[38:39], v[150:151] op_sel_hi:[0,1,1] neg_lo:[1,0,0] neg_hi:[1,0,0]
    v_pk_mul_f32 v[80:81], v[132:133], v[132:133]
    v_pk_mul_f32 v[82:83], v[134:135], v[134:135]
    v_pk_mul_f32 v[84:85], v[148:149], v[148:149]
    v_pk_mul_f32 v[86:87], v[150:151], v[150:151]
    v_pk_fma_f32 v[80:81], v[80:81], v[14:15], v[14:15] op_sel:[0,1,0] op_sel_hi:[1,1,0]
    v_pk_fma_f32 v[82:83], v[82:83], v[14:15], v[14:15] op_sel:[0,1,0] op_sel_hi:[1,1,0]
    v_pk_fma_f32 v[84:85], v[84:85], v[14:15], v[14:15] op_sel:[0,1,0] op_sel_hi:[1,1,0]
    v_pk_fma_f32 v[86:87], v[86:87], v[14:15], v[14:15] op_sel:[0,1,0] op_sel_hi:[1,1,0]
    v_pk_mul_f32 v[80:81], v[80:81], v[132:133]
    v_pk_mul_f32 v[82:83], v[82:83], v[134:135]
    v_pk_mul_f32 v[84:85], v[84:85], v[148:149]
    v_pk_mul_f32 v[86:87], v[86:87], v[150:151]
    v_exp_f32 v80, v80
    v_pk_fma_f32 v[196:197], v[12:13], v[40:41], v[196:197] op_sel_hi:[0,1,1] neg_lo:[1,0,0] neg_hi:[1,0,0]
    v_exp_f32 v81, v81
    v_exp_f32 v82, v82
    v_pk_fma_f32 v[198:199], v[12:13], v[42:43], v[198:199] op_sel_hi:[0,1,1] neg_lo:[1,0,0] neg_hi:[1,0,0]
    v_exp_f32 v83, v83
    v_exp_f32 v84, v84
    v_pk_fma_f32 v[212:213], v[12:13], v[44:45], v[212:213] op_sel_hi:[0,1,1] neg_lo:[1,0,0] neg_hi:[1,0,0]
    v_exp_f32 v85, v85
    v_exp_f32 v86, v86
    v_pk_fma_f32 v[214:215], v[12:13], v[46:47], v[214:215] op_sel_hi:[0,1,1] neg_lo:[1,0,0] neg_hi:[1,0,0]
    v_exp_f32 v87, v87
    v_pk_fma_f32 v[80:81], v[80:81], v[12:13], v[12:13] op_sel:[0,1,1] op_sel_hi:[1,1,1]
    v_pk_fma_f32 v[82:83], v[82:83], v[12:13], v[12:13] op_sel:[0,1,1] op_sel_hi:[1,1,1]
    v_pk_fma_f32 v[84:85], v[84:85], v[12:13], v[12:13] op_sel:[0,1,1] op_sel_hi:[1,1,1]
    v_pk_fma_f32 v[86:87], v[86:87], v[12:13], v[12:13] op_sel:[0,1,1] op_sel_hi:[1,1,1]
    v_rcp_f32 v80, v80
    v_pk_mul_f32 v[132:133], v[132:133], v[196:197]
    v_rcp_f32 v81, v81
    v_rcp_f32 v82, v82
    v_pk_mul_f32 v[134:135], v[134:135], v[198:199]
    v_rcp_f32 v83, v83
    v_rcp_f32 v84, v84
    v_pk_mul_f32 v[148:149], v[148:149], v[212:213]
    v_rcp_f32 v85, v85
    v_rcp_f32 v86, v86
    v_pk_mul_f32 v[150:151], v[150:151], v[214:215]
    v_rcp_f32 v87, v87
    v_pk_mul_f32 v[132:133], v[132:133], v[80:81]
    v_pk_mul_f32 v[134:135], v[134:135], v[82:83]
    v_pk_mul_f32 v[148:149], v[148:149], v[84:85]
    v_pk_mul_f32 v[150:151], v[150:151], v[86:87]
    v_cvt_pk_bf16_f32 v88, v132, v133
    v_cvt_pk_bf16_f32 v89, v134, v135
    v_cvt_pk_bf16_f32 v90, v148, v149
    v_cvt_pk_bf16_f32 v91, v150, v151
    buffer_store_dwordx4 v[88:91], v24, s[44:47], s77 offen offset:1024 sc1
    v_pk_fma_f32 v[136:137], v[16:17], v[32:33], v[136:137] op_sel_hi:[0,1,1] neg_lo:[1,0,0] neg_hi:[1,0,0]
    v_pk_fma_f32 v[138:139], v[16:17], v[34:35], v[138:139] op_sel_hi:[0,1,1] neg_lo:[1,0,0] neg_hi:[1,0,0]
    v_pk_fma_f32 v[152:153], v[16:17], v[36:37], v[152:153] op_sel_hi:[0,1,1] neg_lo:[1,0,0] neg_hi:[1,0,0]
    v_pk_fma_f32 v[154:155], v[16:17], v[38:39], v[154:155] op_sel_hi:[0,1,1] neg_lo:[1,0,0] neg_hi:[1,0,0]
    v_pk_mul_f32 v[64:65], v[136:137], v[136:137]
    v_pk_mul_f32 v[66:67], v[138:139], v[138:139]
    v_pk_mul_f32 v[68:69], v[152:153], v[152:153]
    v_pk_mul_f32 v[70:71], v[154:155], v[154:155]
    v_pk_fma_f32 v[64:65], v[64:65], v[18:19], v[18:19] op_sel:[0,1,0] op_sel_hi:[1,1,0]
    v_pk_fma_f32 v[66:67], v[66:67], v[18:19], v[18:19] op_sel:[0,1,0] op_sel_hi:[1,1,0]
    v_pk_fma_f32 v[68:69], v[68:69], v[18:19], v[18:19] op_sel:[0,1,0] op_sel_hi:[1,1,0]
    v_pk_fma_f32 v[70:71], v[70:71], v[18:19], v[18:19] op_sel:[0,1,0] op_sel_hi:[1,1,0]
    v_pk_mul_f32 v[64:65], v[64:65], v[136:137]
    v_pk_mul_f32 v[66:67], v[66:67], v[138:139]
    v_pk_mul_f32 v[68:69], v[68:69], v[152:153]
    v_pk_mul_f32 v[70:71], v[70:71], v[154:155]
    v_exp_f32 v64, v64
    v_pk_fma_f32 v[200:201], v[16:17], v[40:41], v[200:201] op_sel_hi:[0,1,1] neg_lo:[1,0,0] neg_hi:[1,0,0]
    v_exp_f32 v65, v65
    v_exp_f32 v66, v66
    v_pk_fma_f32 v[202:203], v[16:17], v[42:43], v[202:203] op_sel_hi:[0,1,1] neg_lo:[1,0,0] neg_hi:[1,0,0]
    v_exp_f32 v67, v67
    v_exp_f32 v68, v68
    v_pk_fma_f32 v[216:217], v[16:17], v[44:45], v[216:217] op_sel_hi:[0,1,1] neg_lo:[1,0,0] neg_hi:[1,0,0]
    v_exp_f32 v69, v69
    v_exp_f32 v70, v70
    v_pk_fma_f32 v[218:219], v[16:17], v[46:47], v[218:219] op_sel_hi:[0,1,1] neg_lo:[1,0,0] neg_hi:[1,0,0]
    v_exp_f32 v71, v71
    v_pk_fma_f32 v[64:65], v[64:65], v[16:17], v[16:17] op_sel:[0,1,1] op_sel_hi:[1,1,1]
    v_pk_fma_f32 v[66:67], v[66:67], v[16:17], v[16:17] op_sel:[0,1,1] op_sel_hi:[1,1,1]
    v_pk_fma_f32 v[68:69], v[68:69], v[16:17], v[16:17] op_sel:[0,1,1] op_sel_hi:[1,1,1]
    v_pk_fma_f32 v[70:71], v[70:71], v[16:17], v[16:17] op_sel:[0,1,1] op_sel_hi:[1,1,1]
    v_rcp_f32 v64, v64
    v_pk_mul_f32 v[136:137], v[136:137], v[200:201]
    v_rcp_f32 v65, v65
    v_rcp_f32 v66, v66
    v_pk_mul_f32 v[138:139], v[138:139], v[202:203]
    v_rcp_f32 v67, v67
    v_rcp_f32 v68, v68
    v_pk_mul_f32 v[152:153], v[152:153], v[216:217]
    v_rcp_f32 v69, v69
    v_rcp_f32 v70, v70
    v_pk_mul_f32 v[154:155], v[154:155], v[218:219]
    v_rcp_f32 v71, v71
    v_pk_mul_f32 v[136:137], v[136:137], v[64:65]
    v_pk_mul_f32 v[138:139], v[138:139], v[66:67]
    v_pk_mul_f32 v[152:153], v[152:153], v[68:69]
    v_pk_mul_f32 v[154:155], v[154:155], v[70:71]
    v_cvt_pk_bf16_f32 v72, v136, v137
    v_cvt_pk_bf16_f32 v73, v138, v139
    v_cvt_pk_bf16_f32 v74, v152, v153
    v_cvt_pk_bf16_f32 v75, v154, v155
    buffer_store_dwordx4 v[72:75], v24, s[44:47], s77 offen offset:2048 sc1
    v_pk_fma_f32 v[140:141], v[20:21], v[32:33], v[140:141] op_sel_hi:[0,1,1] neg_lo:[1,0,0] neg_hi:[1,0,0]
    v_pk_fma_f32 v[142:143], v[20:21], v[34:35], v[142:143] op_sel_hi:[0,1,1] neg_lo:[1,0,0] neg_hi:[1,0,0]
    v_pk_fma_f32 v[156:157], v[20:21], v[36:37], v[156:157] op_sel_hi:[0,1,1] neg_lo:[1,0,0] neg_hi:[1,0,0]
    v_pk_fma_f32 v[158:159], v[20:21], v[38:39], v[158:159] op_sel_hi:[0,1,1] neg_lo:[1,0,0] neg_hi:[1,0,0]
    v_pk_mul_f32 v[80:81], v[140:141], v[140:141]
    v_pk_mul_f32 v[82:83], v[142:143], v[142:143]
    v_pk_mul_f32 v[84:85], v[156:157], v[156:157]
    v_pk_mul_f32 v[86:87], v[158:159], v[158:159]
    v_pk_fma_f32 v[80:81], v[80:81], v[22:23], v[22:23] op_sel:[0,1,0] op_sel_hi:[1,1,0]
    v_pk_fma_f32 v[82:83], v[82:83], v[22:23], v[22:23] op_sel:[0,1,0] op_sel_hi:[1,1,0]
    v_pk_fma_f32 v[84:85], v[84:85], v[22:23], v[22:23] op_sel:[0,1,0] op_sel_hi:[1,1,0]
    v_pk_fma_f32 v[86:87], v[86:87], v[22:23], v[22:23] op_sel:[0,1,0] op_sel_hi:[1,1,0]
    v_pk_mul_f32 v[80:81], v[80:81], v[140:141]
    v_pk_mul_f32 v[82:83], v[82:83], v[142:143]
    v_pk_mul_f32 v[84:85], v[84:85], v[156:157]
    v_pk_mul_f32 v[86:87], v[86:87], v[158:159]
    v_exp_f32 v80, v80
    v_pk_fma_f32 v[204:205], v[20:21], v[40:41], v[204:205] op_sel_hi:[0,1,1] neg_lo:[1,0,0] neg_hi:[1,0,0]
    v_exp_f32 v81, v81
    v_exp_f32 v82, v82
    v_pk_fma_f32 v[206:207], v[20:21], v[42:43], v[206:207] op_sel_hi:[0,1,1] neg_lo:[1,0,0] neg_hi:[1,0,0]
    v_exp_f32 v83, v83
    v_exp_f32 v84, v84
    v_pk_fma_f32 v[220:221], v[20:21], v[44:45], v[220:221] op_sel_hi:[0,1,1] neg_lo:[1,0,0] neg_hi:[1,0,0]
    v_exp_f32 v85, v85
    v_exp_f32 v86, v86
    v_pk_fma_f32 v[222:223], v[20:21], v[46:47], v[222:223] op_sel_hi:[0,1,1] neg_lo:[1,0,0] neg_hi:[1,0,0]
    v_exp_f32 v87, v87
    v_pk_fma_f32 v[80:81], v[80:81], v[20:21], v[20:21] op_sel:[0,1,1] op_sel_hi:[1,1,1]
    v_pk_fma_f32 v[82:83], v[82:83], v[20:21], v[20:21] op_sel:[0,1,1] op_sel_hi:[1,1,1]
    v_pk_fma_f32 v[84:85], v[84:85], v[20:21], v[20:21] op_sel:[0,1,1] op_sel_hi:[1,1,1]
    v_pk_fma_f32 v[86:87], v[86:87], v[20:21], v[20:21] op_sel:[0,1,1] op_sel_hi:[1,1,1]
    v_rcp_f32 v80, v80
    v_pk_mul_f32 v[140:141], v[140:141], v[204:205]
    v_rcp_f32 v81, v81
    v_rcp_f32 v82, v82
    v_pk_mul_f32 v[142:143], v[142:143], v[206:207]
    v_rcp_f32 v83, v83
    v_rcp_f32 v84, v84
    v_pk_mul_f32 v[156:157], v[156:157], v[220:221]
    v_rcp_f32 v85, v85
    v_rcp_f32 v86, v86
    v_pk_mul_f32 v[158:159], v[158:159], v[222:223]
    v_rcp_f32 v87, v87
    v_pk_mul_f32 v[140:141], v[140:141], v[80:81]
    v_pk_mul_f32 v[142:143], v[142:143], v[82:83]
    v_pk_mul_f32 v[156:157], v[156:157], v[84:85]
    v_pk_mul_f32 v[158:159], v[158:159], v[86:87]
    v_cvt_pk_bf16_f32 v88, v140, v141
    v_cvt_pk_bf16_f32 v89, v142, v143
    v_cvt_pk_bf16_f32 v90, v156, v157
    v_cvt_pk_bf16_f32 v91, v158, v159
    buffer_store_dwordx4 v[88:91], v24, s[44:47], s77 offen offset:3072 sc1
    s_add_u32 s77, s77, 4096
    v_pk_fma_f32 v[160:161], v[8:9], v[48:49], v[160:161] op_sel_hi:[0,1,1] neg_lo:[1,0,0] neg_hi:[1,0,0]
    v_pk_fma_f32 v[162:163], v[8:9], v[50:51], v[162:163] op_sel_hi:[0,1,1] neg_lo:[1,0,0] neg_hi:[1,0,0]
    v_pk_fma_f32 v[176:177], v[8:9], v[52:53], v[176:177] op_sel_hi:[0,1,1] neg_lo:[1,0,0] neg_hi:[1,0,0]
    v_pk_fma_f32 v[178:179], v[8:9], v[54:55], v[178:179] op_sel_hi:[0,1,1] neg_lo:[1,0,0] neg_hi:[1,0,0]
    v_pk_mul_f32 v[64:65], v[160:161], v[160:161]
    v_pk_mul_f32 v[66:67], v[162:163], v[162:163]
    v_pk_mul_f32 v[68:69], v[176:177], v[176:177]
    v_pk_mul_f32 v[70:71], v[178:179], v[178:179]
    v_pk_fma_f32 v[64:65], v[64:65], v[10:11], v[10:11] op_sel:[0,1,0] op_sel_hi:[1,1,0]
    v_pk_fma_f32 v[66:67], v[66:67], v[10:11], v[10:11] op_sel:[0,1,0] op_sel_hi:[1,1,0]
    v_pk_fma_f32 v[68:69], v[68:69], v[10:11], v[10:11] op_sel:[0,1,0] op_sel_hi:[1,1,0]
    v_pk_fma_f32 v[70:71], v[70:71], v[10:11], v[10:11] op_sel:[0,1,0] op_sel_hi:[1,1,0]
    v_pk_mul_f32 v[64:65], v[64:65], v[160:161]
    v_pk_mul_f32 v[66:67], v[66:67], v[162:163]
    v_pk_mul_f32 v[68:69], v[68:69], v[176:177]
    v_pk_mul_f32 v[70:71], v[70:71], v[178:179]
    v_exp_f32 v64, v64
    v_pk_fma_f32 v[224:225], v[8:9], v[56:57], v[224:225] op_sel_hi:[0,1,1] neg_lo:[1,0,0] neg_hi:[1,0,0]
    v_exp_f32 v65, v65
    v_exp_f32 v66, v66
    v_pk_fma_f32 v[226:227], v[8:9], v[58:59], v[226:227] op_sel_hi:[0,1,1] neg_lo:[1,0,0] neg_hi:[1,0,0]
    v_exp_f32 v67, v67
    v_exp_f32 v68, v68
    v_pk_fma_f32 v[240:241], v[8:9], v[60:61], v[240:241] op_sel_hi:[0,1,1] neg_lo:[1,0,0] neg_hi:[1,0,0]
    v_exp_f32 v69, v69
    v_exp_f32 v70, v70
    v_pk_fma_f32 v[242:243], v[8:9], v[62:63], v[242:243] op_sel_hi:[0,1,1] neg_lo:[1,0,0] neg_hi:[1,0,0]
    v_exp_f32 v71, v71
    v_pk_fma_f32 v[64:65], v[64:65], v[8:9], v[8:9] op_sel:[0,1,1] op_sel_hi:[1,1,1]
    v_pk_fma_f32 v[66:67], v[66:67], v[8:9], v[8:9] op_sel:[0,1,1] op_sel_hi:[1,1,1]
    v_pk_fma_f32 v[68:69], v[68:69], v[8:9], v[8:9] op_sel:[0,1,1] op_sel_hi:[1,1,1]
    v_pk_fma_f32 v[70:71], v[70:71], v[8:9], v[8:9] op_sel:[0,1,1] op_sel_hi:[1,1,1]
    v_rcp_f32 v64, v64
    v_pk_mul_f32 v[160:161], v[160:161], v[224:225]
    v_rcp_f32 v65, v65
    v_rcp_f32 v66, v66
    v_pk_mul_f32 v[162:163], v[162:163], v[226:227]
    v_rcp_f32 v67, v67
    v_rcp_f32 v68, v68
    v_pk_mul_f32 v[176:177], v[176:177], v[240:241]
    v_rcp_f32 v69, v69
    v_rcp_f32 v70, v70
    v_pk_mul_f32 v[178:179], v[178:179], v[242:243]
    v_rcp_f32 v71, v71
    v_pk_mul_f32 v[160:161], v[160:161], v[64:65]
    v_pk_mul_f32 v[162:163], v[162:163], v[66:67]
    v_pk_mul_f32 v[176:177], v[176:177], v[68:69]
    v_pk_mul_f32 v[178:179], v[178:179], v[70:71]
    v_cvt_pk_bf16_f32 v72, v160, v161
    v_cvt_pk_bf16_f32 v73, v162, v163
    v_cvt_pk_bf16_f32 v74, v176, v177
    v_cvt_pk_bf16_f32 v75, v178, v179
    buffer_store_dwordx4 v[72:75], v24, s[44:47], s77 offen offset:0 sc1
    v_pk_fma_f32 v[164:165], v[12:13], v[48:49], v[164:165] op_sel_hi:[0,1,1] neg_lo:[1,0,0] neg_hi:[1,0,0]
    v_pk_fma_f32 v[166:167], v[12:13], v[50:51], v[166:167] op_sel_hi:[0,1,1] neg_lo:[1,0,0] neg_hi:[1,0,0]
    v_pk_fma_f32 v[180:181], v[12:13], v[52:53], v[180:181] op_sel_hi:[0,1,1] neg_lo:[1,0,0] neg_hi:[1,0,0]
    v_pk_fma_f32 v[182:183], v[12:13], v[54:55], v[182:183] op_sel_hi:[0,1,1] neg_lo:[1,0,0] neg_hi:[1,0,0]
    v_pk_mul_f32 v[80:81], v[164:165], v[164:165]
    v_pk_mul_f32 v[82:83], v[166:167], v[166:167]
    v_pk_mul_f32 v[84:85], v[180:181], v[180:181]
    v_pk_mul_f32 v[86:87], v[182:183], v[182:183]
    v_pk_fma_f32 v[80:81], v[80:81], v[14:15], v[14:15] op_sel:[0,1,0] op_sel_hi:[1,1,0]
    v_pk_fma_f32 v[82:83], v[82:83], v[14:15], v[14:15] op_sel:[0,1,0] op_sel_hi:[1,1,0]
    v_pk_fma_f32 v[84:85], v[84:85], v[14:15], v[14:15] op_sel:[0,1,0] op_sel_hi:[1,1,0]
    v_pk_fma_f32 v[86:87], v[86:87], v[14:15], v[14:15] op_sel:[0,1,0] op_sel_hi:[1,1,0]
    v_pk_mul_f32 v[80:81], v[80:81], v[164:165]
    v_pk_mul_f32 v[82:83], v[82:83], v[166:167]
    v_pk_mul_f32 v[84:85], v[84:85], v[180:181]
    v_pk_mul_f32 v[86:87], v[86:87], v[182:183]
    v_exp_f32 v80, v80
    v_pk_fma_f32 v[228:229], v[12:13], v[56:57], v[228:229] op_sel_hi:[0,1,1] neg_lo:[1,0,0] neg_hi:[1,0,0]
    v_exp_f32 v81, v81
    v_exp_f32 v82, v82
    v_pk_fma_f32 v[230:231], v[12:13], v[58:59], v[230:231] op_sel_hi:[0,1,1] neg_lo:[1,0,0] neg_hi:[1,0,0]
    v_exp_f32 v83, v83
    v_exp_f32 v84, v84
    v_pk_fma_f32 v[244:245], v[12:13], v[60:61], v[244:245] op_sel_hi:[0,1,1] neg_lo:[1,0,0] neg_hi:[1,0,0]
    v_exp_f32 v85, v85
    v_exp_f32 v86, v86
    v_pk_fma_f32 v[246:247], v[12:13], v[62:63], v[246:247] op_sel_hi:[0,1,1] neg_lo:[1,0,0] neg_hi:[1,0,0]
    v_exp_f32 v87, v87
    v_pk_fma_f32 v[80:81], v[80:81], v[12:13], v[12:13] op_sel:[0,1,1] op_sel_hi:[1,1,1]
    v_pk_fma_f32 v[82:83], v[82:83], v[12:13], v[12:13] op_sel:[0,1,1] op_sel_hi:[1,1,1]
    v_pk_fma_f32 v[84:85], v[84:85], v[12:13], v[12:13] op_sel:[0,1,1] op_sel_hi:[1,1,1]
    v_pk_fma_f32 v[86:87], v[86:87], v[12:13], v[12:13] op_sel:[0,1,1] op_sel_hi:[1,1,1]
    v_rcp_f32 v80, v80
    v_pk_mul_f32 v[164:165], v[164:165], v[228:229]
    v_rcp_f32 v81, v81
    v_rcp_f32 v82, v82
    v_pk_mul_f32 v[166:167], v[166:167], v[230:231]
    v_rcp_f32 v83, v83
    v_rcp_f32 v84, v84
    v_pk_mul_f32 v[180:181], v[180:181], v[244:245]
    v_rcp_f32 v85, v85
    v_rcp_f32 v86, v86
    v_pk_mul_f32 v[182:183], v[182:183], v[246:247]
    v_rcp_f32 v87, v87
    v_pk_mul_f32 v[164:165], v[164:165], v[80:81]
    v_pk_mul_f32 v[166:167], v[166:167], v[82:83]
    v_pk_mul_f32 v[180:181], v[180:181], v[84:85]
    v_pk_mul_f32 v[182:183], v[182:183], v[86:87]
    v_cvt_pk_bf16_f32 v88, v164, v165
    v_cvt_pk_bf16_f32 v89, v166, v167
    v_cvt_pk_bf16_f32 v90, v180, v181
    v_cvt_pk_bf16_f32 v91, v182, v183
    buffer_store_dwordx4 v[88:91], v24, s[44:47], s77 offen offset:1024 sc1
    v_pk_fma_f32 v[168:169], v[16:17], v[48:49], v[168:169] op_sel_hi:[0,1,1] neg_lo:[1,0,0] neg_hi:[1,0,0]
    v_pk_fma_f32 v[170:171], v[16:17], v[50:51], v[170:171] op_sel_hi:[0,1,1] neg_lo:[1,0,0] neg_hi:[1,0,0]
    v_pk_fma_f32 v[184:185], v[16:17], v[52:53], v[184:185] op_sel_hi:[0,1,1] neg_lo:[1,0,0] neg_hi:[1,0,0]
    v_pk_fma_f32 v[186:187], v[16:17], v[54:55], v[186:187] op_sel_hi:[0,1,1] neg_lo:[1,0,0] neg_hi:[1,0,0]
    v_pk_mul_f32 v[64:65], v[168:169], v[168:169]
    v_pk_mul_f32 v[66:67], v[170:171], v[170:171]
    v_pk_mul_f32 v[68:69], v[184:185], v[184:185]
    v_pk_mul_f32 v[70:71], v[186:187], v[186:187]
    v_pk_fma_f32 v[64:65], v[64:65], v[18:19], v[18:19] op_sel:[0,1,0] op_sel_hi:[1,1,0]
    v_pk_fma_f32 v[66:67], v[66:67], v[18:19], v[18:19] op_sel:[0,1,0] op_sel_hi:[1,1,0]
    v_pk_fma_f32 v[68:69], v[68:69], v[18:19], v[18:19] op_sel:[0,1,0] op_sel_hi:[1,1,0]
    v_pk_fma_f32 v[70:71], v[70:71], v[18:19], v[18:19] op_sel:[0,1,0] op_sel_hi:[1,1,0]
    v_pk_mul_f32 v[64:65], v[64:65], v[168:169]
    v_pk_mul_f32 v[66:67], v[66:67], v[170:171]
    v_pk_mul_f32 v[68:69], v[68:69], v[184:185]
    v_pk_mul_f32 v[70:71], v[70:71], v[186:187]
    v_exp_f32 v64, v64
    v_pk_fma_f32 v[232:233], v[16:17], v[56:57], v[232:233] op_sel_hi:[0,1,1] neg_lo:[1,0,0] neg_hi:[1,0,0]
    v_exp_f32 v65, v65
    v_exp_f32 v66, v66
    v_pk_fma_f32 v[234:235], v[16:17], v[58:59], v[234:235] op_sel_hi:[0,1,1] neg_lo:[1,0,0] neg_hi:[1,0,0]
    v_exp_f32 v67, v67
    v_exp_f32 v68, v68
    v_pk_fma_f32 v[248:249], v[16:17], v[60:61], v[248:249] op_sel_hi:[0,1,1] neg_lo:[1,0,0] neg_hi:[1,0,0]
    v_exp_f32 v69, v69
    v_exp_f32 v70, v70
    v_pk_fma_f32 v[250:251], v[16:17], v[62:63], v[250:251] op_sel_hi:[0,1,1] neg_lo:[1,0,0] neg_hi:[1,0,0]
    v_exp_f32 v71, v71
    v_pk_fma_f32 v[64:65], v[64:65], v[16:17], v[16:17] op_sel:[0,1,1] op_sel_hi:[1,1,1]
    v_pk_fma_f32 v[66:67], v[66:67], v[16:17], v[16:17] op_sel:[0,1,1] op_sel_hi:[1,1,1]
    v_pk_fma_f32 v[68:69], v[68:69], v[16:17], v[16:17] op_sel:[0,1,1] op_sel_hi:[1,1,1]
    v_pk_fma_f32 v[70:71], v[70:71], v[16:17], v[16:17] op_sel:[0,1,1] op_sel_hi:[1,1,1]
    v_rcp_f32 v64, v64
    v_pk_mul_f32 v[168:169], v[168:169], v[232:233]
    v_rcp_f32 v65, v65
    v_rcp_f32 v66, v66
    v_pk_mul_f32 v[170:171], v[170:171], v[234:235]
    v_rcp_f32 v67, v67
    v_rcp_f32 v68, v68
    v_pk_mul_f32 v[184:185], v[184:185], v[248:249]
    v_rcp_f32 v69, v69
    v_rcp_f32 v70, v70
    v_pk_mul_f32 v[186:187], v[186:187], v[250:251]
    v_rcp_f32 v71, v71
    v_pk_mul_f32 v[168:169], v[168:169], v[64:65]
    v_pk_mul_f32 v[170:171], v[170:171], v[66:67]
    v_pk_mul_f32 v[184:185], v[184:185], v[68:69]
    v_pk_mul_f32 v[186:187], v[186:187], v[70:71]
    v_cvt_pk_bf16_f32 v72, v168, v169
    v_cvt_pk_bf16_f32 v73, v170, v171
    v_cvt_pk_bf16_f32 v74, v184, v185
    v_cvt_pk_bf16_f32 v75, v186, v187
    buffer_store_dwordx4 v[72:75], v24, s[44:47], s77 offen offset:2048 sc1
    s_waitcnt vmcnt(3)
    v_mov_b32 v4, 0
    v_mov_b32 v5, 1
    s_mov_b64 exec, 1
    buffer_store_dword v5, v4, s[44:47], s79 offen sc1
    s_mov_b64 exec, -1
    v_pk_fma_f32 v[172:173], v[20:21], v[48:49], v[172:173] op_sel_hi:[0,1,1] neg_lo:[1,0,0] neg_hi:[1,0,0]
    v_pk_fma_f32 v[174:175], v[20:21], v[50:51], v[174:175] op_sel_hi:[0,1,1] neg_lo:[1,0,0] neg_hi:[1,0,0]
    v_pk_fma_f32 v[188:189], v[20:21], v[52:53], v[188:189] op_sel_hi:[0,1,1] neg_lo:[1,0,0] neg_hi:[1,0,0]
    v_pk_fma_f32 v[190:191], v[20:21], v[54:55], v[190:191] op_sel_hi:[0,1,1] neg_lo:[1,0,0] neg_hi:[1,0,0]
    v_pk_mul_f32 v[80:81], v[172:173], v[172:173]
    v_pk_mul_f32 v[82:83], v[174:175], v[174:175]
    v_pk_mul_f32 v[84:85], v[188:189], v[188:189]
    v_pk_mul_f32 v[86:87], v[190:191], v[190:191]
    v_pk_fma_f32 v[80:81], v[80:81], v[22:23], v[22:23] op_sel:[0,1,0] op_sel_hi:[1,1,0]
    v_pk_fma_f32 v[82:83], v[82:83], v[22:23], v[22:23] op_sel:[0,1,0] op_sel_hi:[1,1,0]
    v_pk_fma_f32 v[84:85], v[84:85], v[22:23], v[22:23] op_sel:[0,1,0] op_sel_hi:[1,1,0]
    v_pk_fma_f32 v[86:87], v[86:87], v[22:23], v[22:23] op_sel:[0,1,0] op_sel_hi:[1,1,0]
    v_pk_mul_f32 v[80:81], v[80:81], v[172:173]
    v_pk_mul_f32 v[82:83], v[82:83], v[174:175]
    v_pk_mul_f32 v[84:85], v[84:85], v[188:189]
    v_pk_mul_f32 v[86:87], v[86:87], v[190:191]
    v_exp_f32 v80, v80
    v_pk_fma_f32 v[236:237], v[20:21], v[56:57], v[236:237] op_sel_hi:[0,1,1] neg_lo:[1,0,0] neg_hi:[1,0,0]
    v_exp_f32 v81, v81
    v_exp_f32 v82, v82
    v_pk_fma_f32 v[238:239], v[20:21], v[58:59], v[238:239] op_sel_hi:[0,1,1] neg_lo:[1,0,0] neg_hi:[1,0,0]
    v_exp_f32 v83, v83
    v_exp_f32 v84, v84
    v_pk_fma_f32 v[252:253], v[20:21], v[60:61], v[252:253] op_sel_hi:[0,1,1] neg_lo:[1,0,0] neg_hi:[1,0,0]
    v_exp_f32 v85, v85
    v_exp_f32 v86, v86
    v_pk_fma_f32 v[254:255], v[20:21], v[62:63], v[254:255] op_sel_hi:[0,1,1] neg_lo:[1,0,0] neg_hi:[1,0,0]
    v_exp_f32 v87, v87
    v_pk_fma_f32 v[80:81], v[80:81], v[20:21], v[20:21] op_sel:[0,1,1] op_sel_hi:[1,1,1]
    v_pk_fma_f32 v[82:83], v[82:83], v[20:21], v[20:21] op_sel:[0,1,1] op_sel_hi:[1,1,1]
    v_pk_fma_f32 v[84:85], v[84:85], v[20:21], v[20:21] op_sel:[0,1,1] op_sel_hi:[1,1,1]
    v_pk_fma_f32 v[86:87], v[86:87], v[20:21], v[20:21] op_sel:[0,1,1] op_sel_hi:[1,1,1]
    v_rcp_f32 v80, v80
    v_pk_mul_f32 v[172:173], v[172:173], v[236:237]
    v_rcp_f32 v81, v81
    v_rcp_f32 v82, v82
    v_pk_mul_f32 v[174:175], v[174:175], v[238:239]
    v_rcp_f32 v83, v83
    v_rcp_f32 v84, v84
    v_pk_mul_f32 v[188:189], v[188:189], v[252:253]
    v_rcp_f32 v85, v85
    v_rcp_f32 v86, v86
    v_pk_mul_f32 v[190:191], v[190:191], v[254:255]
    v_rcp_f32 v87, v87
    v_pk_mul_f32 v[172:173], v[172:173], v[80:81]
    v_pk_mul_f32 v[174:175], v[174:175], v[82:83]
    v_pk_mul_f32 v[188:189], v[188:189], v[84:85]
    v_pk_mul_f32 v[190:191], v[190:191], v[86:87]
    v_cvt_pk_bf16_f32 v88, v172, v173
    v_cvt_pk_bf16_f32 v89, v174, v175
    v_cvt_pk_bf16_f32 v90, v188, v189
    v_cvt_pk_bf16_f32 v91, v190, v191
    buffer_store_dwordx4 v[88:91], v24, s[44:47], s77 offen offset:3072 sc1
    v_mov_b32 v5, 1
    ds_write_b32 v29, v5
    s_waitcnt vmcnt(0)
    v_mov_b32 v4, 0
    v_mov_b32 v5, 3
    s_mov_b64 exec, 1
    buffer_store_dword v5, v4, s[44:47], s79 offen sc1
    s_mov_b64 exec, -1
    v_mov_b32 v4, 163164
    s_mov_b32 s73, 200000
LW_13:
    ds_read_b32 v5, v4
    s_waitcnt lgkmcnt(0)
    v_readfirstlane_b32 s72, v5
    s_nop 1
    s_cmp_ge_u32 s72, 1
    s_cbranch_scc1 LWD_14
    s_sub_u32 s73, s73, 1
    s_cmp_eq_u32 s73, 0
    s_cbranch_scc1 LWD_14
    s_sleep 1
    s_branch LW_13
LWD_14:
    buffer_load_dwordx4 v[76:79], v24, s[44:47], s82 offen offset:0 sc1
    buffer_load_dwordx4 v[92:95], v24, s[44:47], s82 offen offset:1024 sc1
    buffer_load_dwordx4 v[96:99], v24, s[44:47], s82 offen offset:2048 sc1
    buffer_load_dwordx4 v[100:103], v24, s[44:47], s82 offen offset:3072 sc1
    buffer_load_dwordx4 v[104:107], v26, s[44:47], s82 offen offset:3072 sc1
    s_cmp_eq_u32 s86, 1
    s_cselect_b32 s91, s90, 10240
    s_add_u32 s82, s82, s91
    buffer_load_dwordx4 v[108:111], v24, s[44:47], s82 offen offset:0 sc1
    buffer_load_dwordx4 v[112:115], v24, s[44:47], s82 offen offset:1024 sc1
    buffer_load_dwordx4 v[116:119], v24, s[44:47], s82 offen offset:2048 sc1
    buffer_load_dwordx4 v[120:123], v24, s[44:47], s82 offen offset:3072 sc1
    buffer_load_dwordx4 v[124:127], v26, s[44:47], s82 offen offset:3072 sc1
    s_cmp_eq_u32 s86, 2
    s_cselect_b32 s91, s90, 10240
    s_add_u32 s82, s82, s91
    buffer_load_dwordx4 v[128:131], v24, s[44:47], s82 offen offset:0 sc1
    buffer_load_dwordx4 v[144:147], v24, s[44:47], s82 offen offset:1024 sc1
    buffer_load_dwordx4 v[192:195], v24, s[44:47], s82 offen offset:2048 sc1
    buffer_load_dwordx4 v[208:211], v24, s[44:47], s82 offen offset:3072 sc1
    buffer_load_dwordx4 v[132:135], v26, s[44:47], s82 offen offset:3072 sc1
    s_cmp_eq_u32 s86, 3
    s_cselect_b32 s91, s90, 10240
    s_add_u32 s82, s82, s91
    buffer_load_dwordx4 v[148:151], v24, s[44:47], s82 offen offset:0 sc1
    buffer_load_dwordx4 v[196:199], v24, s[44:47], s82 offen offset:1024 sc1
    buffer_load_dwordx4 v[212:215], v24, s[44:47], s82 offen offset:2048 sc1
    buffer_load_dwordx4 v[136:139], v24, s[44:47], s82 offen offset:3072 sc1
    buffer_load_dwordx4 v[152:155], v26, s[44:47], s82 offen offset:3072 sc1
    s_cmp_eq_u32 s86, 4
    s_cselect_b32 s91, s90, 10240
    s_add_u32 s82, s82, s91
    buffer_load_dwordx4 v[200:203], v24, s[44:47], s82 offen offset:0 sc1
    buffer_load_dwordx4 v[216:219], v24, s[44:47], s82 offen offset:1024 sc1
    buffer_load_dwordx4 v[140:143], v24, s[44:47], s82 offen offset:2048 sc1
    buffer_load_dwordx4 v[156:159], v24, s[44:47], s82 offen offset:3072 sc1
    buffer_load_dwordx4 v[204:207], v26, s[44:47], s82 offen offset:3072 sc1
    s_branch L_G2
L_G2S:
    s_and_b32 s72, s2, 7
    s_lshr_b32 s73, s2, 3
    s_lshl_b32 s84, s72, 2
    s_and_b32 s74, s73, 3
    s_add_u32 s84, s84, s74
    s_lshr_b32 s85, s73, 2
    s_sub_u32 s73, s3, 1
    s_mul_i32 s73, s73, 14
    s_add_u32 s73, s73, 12
    s_cmp_eq_u32 s3, 0
    s_cselect_b32 s73, 0, s73
    s_cselect_b32 s87, 12, 14
    s_mov_b32 s74, 0
    s_lshr_b32 s86, s87, 1
    s_sub_u32 s75, 3, s87
    s_lshl_b32 s89, s75, 12
    s_mul_i32 s90, s75, 5120
    s_mul_i32 s72, s84, 54
    s_add_u32 s72, s72, s73
    s_add_u32 s72, s72, s74
    s_lshl_b32 s81, s72, 12
    s_mul_i32 s72, s85, 54
    s_add_u32 s72, s72, s73
    s_mul_i32 s88, s72, 5120
    s_add_u32 s88, s88, 12582912
    s_mul_i32 s74, s74, 5120
    s_add_u32 s82, s88, s74
    s_mov_b32 s75, 131072
    s_cmp_eq_u32 s3, 1
    s_cselect_b32 s75, 0, s75
    s_cmp_eq_u32 s3, 2
    s_cselect_b32 s75, 65536, s75
    s_cmp_eq_u32 s3, 3
    s_cselect_b32 s75, 86016, s75
    v_lshlrev_b32 v24, 4, v0
    v_add_u32 v26, 1024, v24
    v_add_u32 v27, s75, v24
    s_lshl_b32 s72, s84, 2
    s_add_u32 s72, s72, s3
    s_mul_i32 s83, s72, 20480
    s_mul_i32 s72, s85, 160
    s_add_u32 s83, s83, s72
    v_mov_b32 v4, 163164
    s_mov_b32 s73, 200000
LW_15:
    ds_read_b32 v5, v4
    s_waitcnt lgkmcnt(0)
    v_readfirstlane_b32 s72, v5
    s_nop 1
    s_cmp_ge_u32 s72, 1
    s_cbranch_scc1 LWD_16
    s_sub_u32 s73, s73, 1
    s_cmp_eq_u32 s73, 0
    s_cbranch_scc1 LWD_16
    s_sleep 4
    s_branch LW_15
LWD_16:
    buffer_load_dwordx4 v[76:79], v24, s[44:47], s82 offen offset:0 sc1
    buffer_load_dwordx4 v[92:95], v24, s[44:47], s82 offen offset:1024 sc1
    buffer_load_dwordx4 v[96:99], v24, s[44:47], s82 offen offset:2048 sc1
    buffer_load_dwordx4 v[100:103], v24, s[44:47], s82 offen offset:3072 sc1
    buffer_load_dwordx4 v[104:107], v26, s[44:47], s82 offen offset:3072 sc1
    s_cmp_eq_u32 s86, 1
    s_cselect_b32 s91, s90, 10240
    s_add_u32 s82, s82, s91
    buffer_load_dwordx4 v[108:111], v24, s[44:47], s82 offen offset:0 sc1
    buffer_load_dwordx4 v[112:115], v24, s[44:47], s82 offen offset:1024 sc1
    buffer_load_dwordx4 v[116:119], v24, s[44:47], s82 offen offset:2048 sc1
    buffer_load_dwordx4 v[120:123], v24, s[44:47], s82 offen offset:3072 sc1
    buffer_load_dwordx4 v[124:127], v26, s[44:47], s82 offen offset:3072 sc1
    s_cmp_eq_u32 s86, 2
    s_cselect_b32 s91, s90, 10240
    s_add_u32 s82, s82, s91
    buffer_load_dwordx4 v[128:131], v24, s[44:47], s82 offen offset:0 sc1
    buffer_load_dwordx4 v[144:147], v24, s[44:47], s82 offen offset:1024 sc1
    buffer_load_dwordx4 v[192:195], v24, s[44:47], s82 offen offset:2048 sc1
    buffer_load_dwordx4 v[208:211], v24, s[44:47], s82 offen offset:3072 sc1
    buffer_load_dwordx4 v[132:135], v26, s[44:47], s82 offen offset:3072 sc1
    s_cmp_eq_u32 s86, 3
    s_cselect_b32 s91, s90, 10240
    s_add_u32 s82, s82, s91
    buffer_load_dwordx4 v[148:151], v24, s[44:47], s82 offen offset:0 sc1
    buffer_load_dwordx4 v[196:199], v24, s[44:47], s82 offen offset:1024 sc1
    buffer_load_dwordx4 v[212:215], v24, s[44:47], s82 offen offset:2048 sc1
    buffer_load_dwordx4 v[136:139], v24, s[44:47], s82 offen offset:3072 sc1
    buffer_load_dwordx4 v[152:155], v26, s[44:47], s82 offen offset:3072 sc1
    s_cmp_eq_u32 s86, 4
    s_cselect_b32 s91, s90, 10240
    s_add_u32 s82, s82, s91
    buffer_load_dwordx4 v[200:203], v24, s[44:47], s82 offen offset:0 sc1
    buffer_load_dwordx4 v[216:219], v24, s[44:47], s82 offen offset:1024 sc1
    buffer_load_dwordx4 v[140:143], v24, s[44:47], s82 offen offset:2048 sc1
    buffer_load_dwordx4 v[156:159], v24, s[44:47], s82 offen offset:3072 sc1
    buffer_load_dwordx4 v[204:207], v26, s[44:47], s82 offen offset:3072 sc1
L_G2:
    s_setprio 1
    s_mov_b32 s64, s38
    s_mov_b32 s65, s39
    s_mov_b32 s66, 2621440
    s_mov_b32 s67, 0x00020000
    v_and_b32 v7, 15, v0
    v_lshrrev_b32 v4, 4, v0
    v_mul_u32_u24 v7, 160, v7
    v_lshl_add_u32 v7, v4, 3, v7
    s_and_b32 s72, s3, 1
    s_mul_i32 s72, s72, 2560
    s_cmp_lt_u32 s3, 2
    s_cselect_b32 s73, 0, 47104
    s_add_u32 s72, s72, s73
    s_add_u32 s72, s72, 59392
    v_add_u32 v1, s72, v7
    v_mov_b32 v4, 163160
    s_mov_b32 s73, 200000
LW_17:
    ds_read_b32 v5, v4
    s_waitcnt lgkmcnt(0)
    v_readfirstlane_b32 s72, v5
    s_nop 1
    s_cmp_ge_u32 s72, 1
    s_cbranch_scc1 LWD_18
    s_sub_u32 s73, s73, 1
    s_cmp_eq_u32 s73, 0
    s_cbranch_scc1 LWD_18
    s_sleep 1
    s_branch LW_17
LWD_18:
    buffer_load_dwordx4 v[8:11], v24, s[44:47], s81 offen offset:0 sc1
    buffer_load_dwordx4 v[12:15], v24, s[44:47], s81 offen offset:1024 sc1
    buffer_load_dwordx4 v[16:19], v24, s[44:47], s81 offen offset:2048 sc1
    buffer_load_dwordx4 v[20:23], v24, s[44:47], s81 offen offset:3072 sc1
    s_cmp_eq_u32 s86, 1
    s_cselect_b32 s91, s89, 8192
    s_add_u32 s81, s81, s91
    buffer_load_dwordx4 v[28:31], v24, s[44:47], s81 offen offset:0 sc1
    buffer_load_dwordx4 v[32:35], v24, s[44:47], s81 offen offset:1024 sc1
    buffer_load_dwordx4 v[36:39], v24, s[44:47], s81 offen offset:2048 sc1
    buffer_load_dwordx4 v[40:43], v24, s[44:47], s81 offen offset:3072 sc1
    s_cmp_eq_u32 s86, 2
    s_cselect_b32 s91, s89, 8192
    s_add_u32 s81, s81, s91
    buffer_load_dwordx4 v[44:47], v24, s[44:47], s81 offen offset:0 sc1
    buffer_load_dwordx4 v[48:51], v24, s[44:47], s81 offen offset:1024 sc1
    buffer_load_dwordx4 v[52:55], v24, s[44:47], s81 offen offset:2048 sc1
    buffer_load_dwordx4 v[56:59], v24, s[44:47], s81 offen offset:3072 sc1
    s_cmp_eq_u32 s86, 3
    s_cselect_b32 s91, s89, 8192
    s_add_u32 s81, s81, s91
    buffer_load_dwordx4 v[60:63], v24, s[44:47], s81 offen offset:0 sc1
    buffer_load_dwordx4 v[64:67], v24, s[44:47], s81 offen offset:1024 sc1
    buffer_load_dwordx4 v[68:71], v24, s[44:47], s81 offen offset:2048 sc1
    buffer_load_dwordx4 v[72:75], v24, s[44:47], s81 offen offset:3072 sc1
    s_cmp_lg_u32 s3, 0
    s_cbranch_scc1 L_G2B
    s_waitcnt vmcnt(12)
    v_mfma_f32_16x16x32_bf16 v[80:83], v[76:79], v[8:11], 0
    v_mfma_f32_16x16x32_bf16 v[84:87], v[76:79], v[12:15], 0
    v_mfma_f32_16x16x32_bf16 v[88:91], v[76:79], v[16:19], 0
    v_mfma_f32_16x16x32_bf16 v[160:163], v[76:79], v[20:23], 0
    v_mfma_f32_16x16x32_bf16 v[164:167], v[92:95], v[8:11], 0
    v_mfma_f32_16x16x32_bf16 v[168:171], v[92:95], v[12:15], 0
    v_mfma_f32_16x16x32_bf16 v[172:175], v[92:95], v[16:19], 0
    v_mfma_f32_16x16x32_bf16 v[176:179], v[92:95], v[20:23], 0
    v_mfma_f32_16x16x32_bf16 v[180:183], v[96:99], v[8:11], 0
    v_mfma_f32_16x16x32_bf16 v[184:187], v[96:99], v[12:15], 0
    v_mfma_f32_16x16x32_bf16 v[188:191], v[96:99], v[16:19], 0
    v_mfma_f32_16x16x32_bf16 v[220:223], v[96:99], v[20:23], 0
    v_mfma_f32_16x16x32_bf16 v[224:227], v[100:103], v[8:11], 0
    v_mfma_f32_16x16x32_bf16 v[228:231], v[100:103], v[12:15], 0
    v_mfma_f32_16x16x32_bf16 v[232:235], v[100:103], v[16:19], 0
    v_mfma_f32_16x16x32_bf16 v[236:239], v[100:103], v[20:23], 0
    v_mfma_f32_16x16x32_bf16 v[240:243], v[104:107], v[8:11], 0
    v_mfma_f32_16x16x32_bf16 v[244:247], v[104:107], v[12:15], 0
    v_mfma_f32_16x16x32_bf16 v[248:251], v[104:107], v[16:19], 0
    v_mfma_f32_16x16x32_bf16 v[252:255], v[104:107], v[20:23], 0
    s_waitcnt vmcnt(8)
    v_mfma_f32_16x16x32_bf16 v[80:83], v[108:111], v[28:31], v[80:83]
    s_cmp_eq_u32 s86, 4
    s_cselect_b32 s91, s89, 8192
    s_add_u32 s81, s81, s91
    buffer_load_dwordx4 v[8:11], v24, s[44:47], s81 offen offset:0 sc1
    v_mfma_f32_16x16x32_bf16 v[84:87], v[108:111], v[32:35], v[84:87]
    v_mfma_f32_16x16x32_bf16 v[88:91], v[108:111], v[36:39], v[88:91]
    buffer_load_dwordx4 v[12:15], v24, s[44:47], s81 offen offset:1024 sc1
    v_mfma_f32_16x16x32_bf16 v[160:163], v[108:111], v[40:43], v[160:163]
    v_mfma_f32_16x16x32_bf16 v[164:167], v[112:115], v[28:31], v[164:167]
    buffer_load_dwordx4 v[16:19], v24, s[44:47], s81 offen offset:2048 sc1
    v_mfma_f32_16x16x32_bf16 v[168:171], v[112:115], v[32:35], v[168:171]
    v_mfma_f32_16x16x32_bf16 v[172:175], v[112:115], v[36:39], v[172:175]
    buffer_load_dwordx4 v[20:23], v24, s[44:47], s81 offen offset:3072 sc1
    v_mfma_f32_16x16x32_bf16 v[176:179], v[112:115], v[40:43], v[176:179]
    v_mfma_f32_16x16x32_bf16 v[180:183], v[116:119], v[28:31], v[180:183]
    s_cmp_eq_u32 s86, 5
    s_cselect_b32 s91, s90, 10240
    s_add_u32 s82, s82, s91
    buffer_load_dwordx4 v[76:79], v24, s[44:47], s82 offen offset:0 sc1
    v_mfma_f32_16x16x32_bf16 v[184:187], v[116:119], v[32:35], v[184:187]
    v_mfma_f32_16x16x32_bf16 v[188:191], v[116:119], v[36:39], v[188:191]
    buffer_load_dwordx4 v[92:95], v24, s[44:47], s82 offen offset:1024 sc1
    v_mfma_f32_16x16x32_bf16 v[220:223], v[116:119], v[40:43], v[220:223]
    v_mfma_f32_16x16x32_bf16 v[224:227], v[120:123], v[28:31], v[224:227]
    buffer_load_dwordx4 v[96:99], v24, s[44:47], s82 offen offset:2048 sc1
    v_mfma_f32_16x16x32_bf16 v[228:231], v[120:123], v[32:35], v[228:231]
    v_mfma_f32_16x16x32_bf16 v[232:235], v[120:123], v[36:39], v[232:235]
    buffer_load_dwordx4 v[100:103], v24, s[44:47], s82 offen offset:3072 sc1
    v_mfma_f32_16x16x32_bf16 v[236:239], v[120:123], v[40:43], v[236:239]
    v_mfma_f32_16x16x32_bf16 v[240:243], v[124:127], v[28:31], v[240:243]
    buffer_load_dwordx4 v[104:107], v26, s[44:47], s82 offen offset:3072 sc1
    v_mfma_f32_16x16x32_bf16 v[244:247], v[124:127], v[32:35], v[244:247]
    v_mfma_f32_16x16x32_bf16 v[248:251], v[124:127], v[36:39], v[248:251]
    v_mfma_f32_16x16x32_bf16 v[252:255], v[124:127], v[40:43], v[252:255]
    s_waitcnt vmcnt(13)
    v_mfma_f32_16x16x32_bf16 v[80:83], v[128:131], v[44:47], v[80:83]
    s_cmp_eq_u32 s86, 5
    s_cselect_b32 s91, s89, 8192
    s_add_u32 s81, s81, s91
    buffer_load_dwordx4 v[28:31], v24, s[44:47], s81 offen offset:0 sc1
    v_mfma_f32_16x16x32_bf16 v[84:87], v[128:131], v[48:51], v[84:87]
    v_mfma_f32_16x16x32_bf16 v[88:91], v[128:131], v[52:55], v[88:91]
    buffer_load_dwordx4 v[32:35], v24, s[44:47], s81 offen offset:1024 sc1
    v_mfma_f32_16x16x32_bf16 v[160:163], v[128:131], v[56:59], v[160:163]
    v_mfma_f32_16x16x32_bf16 v[164:167], v[144:147], v[44:47], v[164:167]
    buffer_load_dwordx4 v[36:39], v24, s[44:47], s81 offen offset:2048 sc1
    v_mfma_f32_16x16x32_bf16 v[168:171], v[144:147], v[48:51], v[168:171]
    v_mfma_f32_16x16x32_bf16 v[172:175], v[144:147], v[52:55], v[172:175]
    buffer_load_dwordx4 v[40:43], v24, s[44:47], s81 offen offset:3072 sc1
    v_mfma_f32_16x16x32_bf16 v[176:179], v[144:147], v[56:59], v[176:179]
    v_mfma_f32_16x16x32_bf16 v[180:183], v[192:195], v[44:47], v[180:183]
    s_cmp_eq_u32 s86, 6
    s_cselect_b32 s91, s90, 10240
    s_add_u32 s82, s82, s91
    buffer_load_dwordx4 v[108:111], v24, s[44:47], s82 offen offset:0 sc1
    v_mfma_f32_16x16x32_bf16 v[184:187], v[192:195], v[48:51], v[184:187]
    v_mfma_f32_16x16x32_bf16 v[188:191], v[192:195], v[52:55], v[188:191]
    buffer_load_dwordx4 v[112:115], v24, s[44:47], s82 offen offset:1024 sc1
    v_mfma_f32_16x16x32_bf16 v[220:223], v[192:195], v[56:59], v[220:223]
    v_mfma_f32_16x16x32_bf16 v[224:227], v[208:211], v[44:47], v[224:227]
    buffer_load_dwordx4 v[116:119], v24, s[44:47], s82 offen offset:2048 sc1
    v_mfma_f32_16x16x32_bf16 v[228:231], v[208:211], v[48:51], v[228:231]
    v_mfma_f32_16x16x32_bf16 v[232:235], v[208:211], v[52:55], v[232:235]
    buffer_load_dwordx4 v[120:123], v24, s[44:47], s82 offen offset:3072 sc1
    v_mfma_f32_16x16x32_bf16 v[236:239], v[208:211], v[56:59], v[236:239]
    v_mfma_f32_16x16x32_bf16 v[240:243], v[132:135], v[44:47], v[240:243]
    buffer_load_dwordx4 v[124:127], v26, s[44:47], s82 offen offset:3072 sc1
    v_mfma_f32_16x16x32_bf16 v[244:247], v[132:135], v[48:51], v[244:247]
    v_mfma_f32_16x16x32_bf16 v[248:251], v[132:135], v[52:55], v[248:251]
    v_mfma_f32_16x16x32_bf16 v[252:255], v[132:135], v[56:59], v[252:255]
    s_waitcnt vmcnt(18)
    v_mov_b32 v4, 163160
    s_mov_b32 s73, 200000
LW_19:
    ds_read_b32 v5, v4
    s_waitcnt lgkmcnt(0)
    v_readfirstlane_b32 s72, v5
    s_nop 1
    s_cmp_ge_u32 s72, 2
    s_cbranch_scc1 LWD_20
    s_sub_u32 s73, s73, 1
    s_cmp_eq_u32 s73, 0
    s_cbranch_scc1 LWD_20
    s_sleep 0
    s_branch LW_19
LWD_20:
    v_mfma_f32_16x16x32_bf16 v[80:83], v[148:151], v[60:63], v[80:83]
    s_cmp_eq_u32 s86, 6
    s_cselect_b32 s91, s89, 8192
    s_add_u32 s81, s81, s91
    buffer_load_dwordx4 v[44:47], v24, s[44:47], s81 offen offset:0 sc1
    v_mfma_f32_16x16x32_bf16 v[84:87], v[148:151], v[64:67], v[84:87]
    v_mfma_f32_16x16x32_bf16 v[88:91], v[148:151], v[68:71], v[88:91]
    buffer_load_dwordx4 v[48:51], v24, s[44:47], s81 offen offset:1024 sc1
    v_mfma_f32_16x16x32_bf16 v[160:163], v[148:151], v[72:75], v[160:163]
    v_mfma_f32_16x16x32_bf16 v[164:167], v[196:199], v[60:63], v[164:167]
    buffer_load_dwordx4 v[52:55], v24, s[44:47], s81 offen offset:2048 sc1
    v_mfma_f32_16x16x32_bf16 v[168:171], v[196:199], v[64:67], v[168:171]
    v_mfma_f32_16x16x32_bf16 v[172:175], v[196:199], v[68:71], v[172:175]
    buffer_load_dwordx4 v[56:59], v24, s[44:47], s81 offen offset:3072 sc1
    v_mfma_f32_16x16x32_bf16 v[176:179], v[196:199], v[72:75], v[176:179]
    v_mfma_f32_16x16x32_bf16 v[180:183], v[212:215], v[60:63], v[180:183]
    s_cmp_eq_u32 s86, 7
    s_cselect_b32 s91, s90, 10240
    s_add_u32 s82, s82, s91
    buffer_load_dwordx4 v[128:131], v24, s[44:47], s82 offen offset:0 sc1
    v_mfma_f32_16x16x32_bf16 v[184:187], v[212:215], v[64:67], v[184:187]
    v_mfma_f32_16x16x32_bf16 v[188:191], v[212:215], v[68:71], v[188:191]
    buffer_load_dwordx4 v[144:147], v24, s[44:47], s82 offen offset:1024 sc1
    v_mfma_f32_16x16x32_bf16 v[220:223], v[212:215], v[72:75], v[220:223]
    v_mfma_f32_16x16x32_bf16 v[224:227], v[136:139], v[60:63], v[224:227]
    buffer_load_dwordx4 v[192:195], v24, s[44:47], s82 offen offset:2048 sc1
    v_mfma_f32_16x16x32_bf16 v[228:231], v[136:139], v[64:67], v[228:231]
    v_mfma_f32_16x16x32_bf16 v[232:235], v[136:139], v[68:71], v[232:235]
    buffer_load_dwordx4 v[208:211], v24, s[44:47], s82 offen offset:3072 sc1
    v_mfma_f32_16x16x32_bf16 v[236:239], v[136:139], v[72:75], v[236:239]
    v_mfma_f32_16x16x32_bf16 v[240:243], v[152:155], v[60:63], v[240:243]
    buffer_load_dwordx4 v[132:135], v26, s[44:47], s82 offen offset:3072 sc1
    v_mfma_f32_16x16x32_bf16 v[244:247], v[152:155], v[64:67], v[244:247]
    v_mfma_f32_16x16x32_bf16 v[248:251], v[152:155], v[68:71], v[248:251]
    v_mfma_f32_16x16x32_bf16 v[252:255], v[152:155], v[72:75], v[252:255]
    s_waitcnt vmcnt(23)
    v_mfma_f32_16x16x32_bf16 v[80:83], v[200:203], v[8:11], v[80:83]
    s_cmp_eq_u32 s86, 7
    s_cselect_b32 s91, s89, 8192
    s_add_u32 s81, s81, s91
    buffer_load_dwordx4 v[60:63], v24, s[44:47], s81 offen offset:0 sc1
    v_mfma_f32_16x16x32_bf16 v[84:87], v[200:203], v[12:15], v[84:87]
    v_mfma_f32_16x16x32_bf16 v[88:91], v[200:203], v[16:19], v[88:91]
    buffer_load_dwordx4 v[64:67], v24, s[44:47], s81 offen offset:1024 sc1
    v_mfma_f32_16x16x32_bf16 v[160:163], v[200:203], v[20:23], v[160:163]
    v_mfma_f32_16x16x32_bf16 v[164:167], v[216:219], v[8:11], v[164:167]
    buffer_load_dwordx4 v[68:71], v24, s[44:47], s81 offen offset:2048 sc1
    v_mfma_f32_16x16x32_bf16 v[168:171], v[216:219], v[12:15], v[168:171]
    v_mfma_f32_16x16x32_bf16 v[172:175], v[216:219], v[16:19], v[172:175]
    buffer_load_dwordx4 v[72:75], v24, s[44:47], s81 offen offset:3072 sc1
    v_mfma_f32_16x16x32_bf16 v[176:179], v[216:219], v[20:23], v[176:179]
    v_mfma_f32_16x16x32_bf16 v[180:183], v[140:143], v[8:11], v[180:183]
    s_cmp_eq_u32 s86, 8
    s_cselect_b32 s91, s90, 10240
    s_add_u32 s82, s82, s91
    buffer_load_dwordx4 v[148:151], v24, s[44:47], s82 offen offset:0 sc1
    v_mfma_f32_16x16x32_bf16 v[184:187], v[140:143], v[12:15], v[184:187]
    v_mfma_f32_16x16x32_bf16 v[188:191], v[140:143], v[16:19], v[188:191]
    buffer_load_dwordx4 v[196:199], v24, s[44:47], s82 offen offset:1024 sc1
    v_mfma_f32_16x16x32_bf16 v[220:223], v[140:143], v[20:23], v[220:223]
    v_mfma_f32_16x16x32_bf16 v[224:227], v[156:159], v[8:11], v[224:227]
    buffer_load_dwordx4 v[212:215], v24, s[44:47], s82 offen offset:2048 sc1
    v_mfma_f32_16x16x32_bf16 v[228:231], v[156:159], v[12:15], v[228:231]
    v_mfma_f32_16x16x32_bf16 v[232:235], v[156:159], v[16:19], v[232:235]
    buffer_load_dwordx4 v[136:139], v24, s[44:47], s82 offen offset:3072 sc1
    v_mfma_f32_16x16x32_bf16 v[236:239], v[156:159], v[20:23], v[236:239]
    v_mfma_f32_16x16x32_bf16 v[240:243], v[204:207], v[8:11], v[240:243]
    buffer_load_dwordx4 v[152:155], v26, s[44:47], s82 offen offset:3072 sc1
    v_mfma_f32_16x16x32_bf16 v[244:247], v[204:207], v[12:15], v[244:247]
    v_mfma_f32_16x16x32_bf16 v[248:251], v[204:207], v[16:19], v[248:251]
    v_mfma_f32_16x16x32_bf16 v[252:255], v[204:207], v[20:23], v[252:255]
    s_waitcnt vmcnt(23)
    v_mov_b32 v4, 163232
    s_mov_b32 s73, 200000
LW_21:
    ds_read_b32 v5, v4
    s_waitcnt lgkmcnt(0)
    v_readfirstlane_b32 s72, v5
    s_nop 1
    s_cmp_ge_u32 s72, 1
    s_cbranch_scc1 LWD_22
    s_sub_u32 s73, s73, 1
    s_cmp_eq_u32 s73, 0
    s_cbranch_scc1 LWD_22
    s_sleep 1
    s_branch LW_21
LWD_22:
    v_mfma_f32_16x16x32_bf16 v[80:83], v[76:79], v[28:31], v[80:83]
    s_cmp_eq_u32 s86, 8
    s_cselect_b32 s91, s89, 8192
    s_add_u32 s81, s81, s91
    buffer_load_dwordx4 v[8:11], v24, s[44:47], s81 offen offset:0 sc1
    v_mfma_f32_16x16x32_bf16 v[84:87], v[76:79], v[32:35], v[84:87]
    v_mfma_f32_16x16x32_bf16 v[88:91], v[76:79], v[36:39], v[88:91]
    buffer_load_dwordx4 v[12:15], v24, s[44:47], s81 offen offset:1024 sc1
    v_mfma_f32_16x16x32_bf16 v[160:163], v[76:79], v[40:43], v[160:163]
    v_mfma_f32_16x16x32_bf16 v[164:167], v[92:95], v[28:31], v[164:167]
    buffer_load_dwordx4 v[16:19], v24, s[44:47], s81 offen offset:2048 sc1
    v_mfma_f32_16x16x32_bf16 v[168:171], v[92:95], v[32:35], v[168:171]
    v_mfma_f32_16x16x32_bf16 v[172:175], v[92:95], v[36:39], v[172:175]
    buffer_load_dwordx4 v[20:23], v24, s[44:47], s81 offen offset:3072 sc1
    v_mfma_f32_16x16x32_bf16 v[176:179], v[92:95], v[40:43], v[176:179]
    v_mfma_f32_16x16x32_bf16 v[180:183], v[96:99], v[28:31], v[180:183]
    ds_read_b128 v[200:203], v27 offset:0
    v_mfma_f32_16x16x32_bf16 v[184:187], v[96:99], v[32:35], v[184:187]
    v_mfma_f32_16x16x32_bf16 v[188:191], v[96:99], v[36:39], v[188:191]
    ds_read_b128 v[216:219], v27 offset:1024
    v_mfma_f32_16x16x32_bf16 v[220:223], v[96:99], v[40:43], v[220:223]
    v_mfma_f32_16x16x32_bf16 v[224:227], v[100:103], v[28:31], v[224:227]
    ds_read_b128 v[140:143], v27 offset:2048
    v_mfma_f32_16x16x32_bf16 v[228:231], v[100:103], v[32:35], v[228:231]
    v_mfma_f32_16x16x32_bf16 v[232:235], v[100:103], v[36:39], v[232:235]
    ds_read_b128 v[156:159], v27 offset:3072
    v_mfma_f32_16x16x32_bf16 v[236:239], v[100:103], v[40:43], v[236:239]
    v_mfma_f32_16x16x32_bf16 v[240:243], v[104:107], v[28:31], v[240:243]
    ds_read_b128 v[204:207], v27 offset:4096
    v_mfma_f32_16x16x32_bf16 v[244:247], v[104:107], v[32:35], v[244:247]
    v_mfma_f32_16x16x32_bf16 v[248:251], v[104:107], v[36:39], v[248:251]
    v_mfma_f32_16x16x32_bf16 v[252:255], v[104:107], v[40:43], v[252:255]
    s_waitcnt vmcnt(18)
    v_mfma_f32_16x16x32_bf16 v[80:83], v[108:111], v[44:47], v[80:83]
    s_cmp_eq_u32 s86, 9
    s_cselect_b32 s91, s89, 8192
    s_add_u32 s81, s81, s91
    buffer_load_dwordx4 v[28:31], v24, s[44:47], s81 offen offset:0 sc1
    v_mfma_f32_16x16x32_bf16 v[84:87], v[108:111], v[48:51], v[84:87]
    v_mfma_f32_16x16x32_bf16 v[88:91], v[108:111], v[52:55], v[88:91]
    buffer_load_dwordx4 v[32:35], v24, s[44:47], s81 offen offset:1024 sc1
    v_mfma_f32_16x16x32_bf16 v[160:163], v[108:111], v[56:59], v[160:163]
    v_mfma_f32_16x16x32_bf16 v[164:167], v[112:115], v[44:47], v[164:167]
    buffer_load_dwordx4 v[36:39], v24, s[44:47], s81 offen offset:2048 sc1
    v_mfma_f32_16x16x32_bf16 v[168:171], v[112:115], v[48:51], v[168:171]
    v_mfma_f32_16x16x32_bf16 v[172:175], v[112:115], v[52:55], v[172:175]
    buffer_load_dwordx4 v[40:43], v24, s[44:47], s81 offen offset:3072 sc1
    v_mfma_f32_16x16x32_bf16 v[176:179], v[112:115], v[56:59], v[176:179]
    v_mfma_f32_16x16x32_bf16 v[180:183], v[116:119], v[44:47], v[180:183]
    ds_read_b128 v[76:79], v27 offset:5120
    v_mfma_f32_16x16x32_bf16 v[184:187], v[116:119], v[48:51], v[184:187]
    v_mfma_f32_16x16x32_bf16 v[188:191], v[116:119], v[52:55], v[188:191]
    ds_read_b128 v[92:95], v27 offset:6144
    v_mfma_f32_16x16x32_bf16 v[220:223], v[116:119], v[56:59], v[220:223]
    v_mfma_f32_16x16x32_bf16 v[224:227], v[120:123], v[44:47], v[224:227]
    ds_read_b128 v[96:99], v27 offset:7168
    v_mfma_f32_16x16x32_bf16 v[228:231], v[120:123], v[48:51], v[228:231]
    v_mfma_f32_16x16x32_bf16 v[232:235], v[120:123], v[52:55], v[232:235]
    ds_read_b128 v[100:103], v27 offset:8192
    v_mfma_f32_16x16x32_bf16 v[236:239], v[120:123], v[56:59], v[236:239]
    v_mfma_f32_16x16x32_bf16 v[240:243], v[124:127], v[44:47], v[240:243]
    ds_read_b128 v[104:107], v27 offset:9216
    v_mfma_f32_16x16x32_bf16 v[244:247], v[124:127], v[48:51], v[244:247]
    v_mfma_f32_16x16x32_bf16 v[248:251], v[124:127], v[52:55], v[248:251]
    v_mfma_f32_16x16x32_bf16 v[252:255], v[124:127], v[56:59], v[252:255]
    s_waitcnt vmcnt(13)
    v_mfma_f32_16x16x32_bf16 v[80:83], v[128:131], v[60:63], v[80:83]
    s_cmp_eq_u32 s86, 10
    s_cselect_b32 s91, s89, 8192
    s_add_u32 s81, s81, s91
    buffer_load_dwordx4 v[44:47], v24, s[44:47], s81 offen offset:0 sc1
    v_mfma_f32_16x16x32_bf16 v[84:87], v[128:131], v[64:67], v[84:87]
    v_mfma_f32_16x16x32_bf16 v[88:91], v[128:131], v[68:71], v[88:91]
    buffer_load_dwordx4 v[48:51], v24, s[44:47], s81 offen offset:1024 sc1
    v_mfma_f32_16x16x32_bf16 v[160:163], v[128:131], v[72:75], v[160:163]
    v_mfma_f32_16x16x32_bf16 v[164:167], v[144:147], v[60:63], v[164:167]
    buffer_load_dwordx4 v[52:55], v24, s[44:47], s81 offen offset:2048 sc1
    v_mfma_f32_16x16x32_bf16 v[168:171], v[144:147], v[64:67], v[168:171]
    v_mfma_f32_16x16x32_bf16 v[172:175], v[144:147], v[68:71], v[172:175]
    buffer_load_dwordx4 v[56:59], v24, s[44:47], s81 offen offset:3072 sc1
    v_mfma_f32_16x16x32_bf16 v[176:179], v[144:147], v[72:75], v[176:179]
    v_mfma_f32_16x16x32_bf16 v[180:183], v[192:195], v[60:63], v[180:183]
    ds_read_b128 v[108:111], v27 offset:10240
    v_mfma_f32_16x16x32_bf16 v[184:187], v[192:195], v[64:67], v[184:187]
    v_mfma_f32_16x16x32_bf16 v[188:191], v[192:195], v[68:71], v[188:191]
    ds_read_b128 v[112:115], v27 offset:11264
    v_mfma_f32_16x16x32_bf16 v[220:223], v[192:195], v[72:75], v[220:223]
    v_mfma_f32_16x16x32_bf16 v[224:227], v[208:211], v[60:63], v[224:227]
    ds_read_b128 v[116:119], v27 offset:12288
    v_mfma_f32_16x16x32_bf16 v[228:231], v[208:211], v[64:67], v[228:231]
    v_mfma_f32_16x16x32_bf16 v[232:235], v[208:211], v[68:71], v[232:235]
    ds_read_b128 v[120:123], v27 offset:13312
    v_mfma_f32_16x16x32_bf16 v[236:239], v[208:211], v[72:75], v[236:239]
    v_mfma_f32_16x16x32_bf16 v[240:243], v[132:135], v[60:63], v[240:243]
    ds_read_b128 v[124:127], v27 offset:14336
    v_mfma_f32_16x16x32_bf16 v[244:247], v[132:135], v[64:67], v[244:247]
    v_mfma_f32_16x16x32_bf16 v[248:251], v[132:135], v[68:71], v[248:251]
    v_mfma_f32_16x16x32_bf16 v[252:255], v[132:135], v[72:75], v[252:255]
    s_waitcnt vmcnt(8)
    v_mfma_f32_16x16x32_bf16 v[80:83], v[148:151], v[8:11], v[80:83]
    s_cmp_eq_u32 s86, 11
    s_cselect_b32 s91, s89, 8192
    s_add_u32 s81, s81, s91
    buffer_load_dwordx4 v[60:63], v24, s[44:47], s81 offen offset:0 sc1
    v_mfma_f32_16x16x32_bf16 v[84:87], v[148:151], v[12:15], v[84:87]
    v_mfma_f32_16x16x32_bf16 v[88:91], v[148:151], v[16:19], v[88:91]
    buffer_load_dwordx4 v[64:67], v24, s[44:47], s81 offen offset:1024 sc1
    v_mfma_f32_16x16x32_bf16 v[160:163], v[148:151], v[20:23], v[160:163]
    v_mfma_f32_16x16x32_bf16 v[164:167], v[196:199], v[8:11], v[164:167]
    buffer_load_dwordx4 v[68:71], v24, s[44:47], s81 offen offset:2048 sc1
    v_mfma_f32_16x16x32_bf16 v[168:171], v[196:199], v[12:15], v[168:171]
    v_mfma_f32_16x16x32_bf16 v[172:175], v[196:199], v[16:19], v[172:175]
    buffer_load_dwordx4 v[72:75], v24, s[44:47], s81 offen offset:3072 sc1
    v_mfma_f32_16x16x32_bf16 v[176:179], v[196:199], v[20:23], v[176:179]
    v_mfma_f32_16x16x32_bf16 v[180:183], v[212:215], v[8:11], v[180:183]
    s_lshl_b32 s72, s3, 2
    v_mov_b32 v4, 163248
    v_add_u32 v4, s72, v4
    v_mov_b32 v5, 1
    ds_write_b32 v4, v5
    v_mfma_f32_16x16x32_bf16 v[184:187], v[212:215], v[12:15], v[184:187]
    v_mfma_f32_16x16x32_bf16 v[188:191], v[212:215], v[16:19], v[188:191]
    v_mfma_f32_16x16x32_bf16 v[220:223], v[212:215], v[20:23], v[220:223]
    v_mfma_f32_16x16x32_bf16 v[224:227], v[136:139], v[8:11], v[224:227]
    v_mfma_f32_16x16x32_bf16 v[228:231], v[136:139], v[12:15], v[228:231]
    v_mfma_f32_16x16x32_bf16 v[232:235], v[136:139], v[16:19], v[232:235]
    v_mfma_f32_16x16x32_bf16 v[236:239], v[136:139], v[20:23], v[236:239]
    v_mfma_f32_16x16x32_bf16 v[240:243], v[152:155], v[8:11], v[240:243]
    v_mfma_f32_16x16x32_bf16 v[244:247], v[152:155], v[12:15], v[244:247]
    v_mfma_f32_16x16x32_bf16 v[248:251], v[152:155], v[16:19], v[248:251]
    v_mfma_f32_16x16x32_bf16 v[252:255], v[152:155], v[20:23], v[252:255]
    s_waitcnt vmcnt(8) lgkmcnt(11)
    v_mfma_f32_16x16x32_bf16 v[80:83], v[200:203], v[28:31], v[80:83]
    v_mfma_f32_16x16x32_bf16 v[84:87], v[200:203], v[32:35], v[84:87]
    v_mfma_f32_16x16x32_bf16 v[88:91], v[200:203], v[36:39], v[88:91]
    v_mfma_f32_16x16x32_bf16 v[160:163], v[200:203], v[40:43], v[160:163]
    v_mfma_f32_16x16x32_bf16 v[164:167], v[216:219], v[28:31], v[164:167]
    v_mfma_f32_16x16x32_bf16 v[168:171], v[216:219], v[32:35], v[168:171]
    v_mfma_f32_16x16x32_bf16 v[172:175], v[216:219], v[36:39], v[172:175]
    v_mfma_f32_16x16x32_bf16 v[176:179], v[216:219], v[40:43], v[176:179]
    v_mfma_f32_16x16x32_bf16 v[180:183], v[140:143], v[28:31], v[180:183]
    v_mfma_f32_16x16x32_bf16 v[184:187], v[140:143], v[32:35], v[184:187]
    v_mfma_f32_16x16x32_bf16 v[188:191], v[140:143], v[36:39], v[188:191]
    v_mfma_f32_16x16x32_bf16 v[220:223], v[140:143], v[40:43], v[220:223]
    v_mfma_f32_16x16x32_bf16 v[224:227], v[156:159], v[28:31], v[224:227]
    v_mfma_f32_16x16x32_bf16 v[228:231], v[156:159], v[32:35], v[228:231]
    v_mfma_f32_16x16x32_bf16 v[232:235], v[156:159], v[36:39], v[232:235]
    v_mfma_f32_16x16x32_bf16 v[236:239], v[156:159], v[40:43], v[236:239]
    v_mfma_f32_16x16x32_bf16 v[240:243], v[204:207], v[28:31], v[240:243]
    v_mfma_f32_16x16x32_bf16 v[244:247], v[204:207], v[32:35], v[244:247]
    v_mfma_f32_16x16x32_bf16 v[248:251], v[204:207], v[36:39], v[248:251]
    v_mfma_f32_16x16x32_bf16 v[252:255], v[204:207], v[40:43], v[252:255]
    s_waitcnt vmcnt(4) lgkmcnt(6)
    v_mfma_f32_16x16x32_bf16 v[80:83], v[76:79], v[44:47], v[80:83]
    v_mfma_f32_16x16x32_bf16 v[84:87], v[76:79], v[48:51], v[84:87]
    v_mfma_f32_16x16x32_bf16 v[88:91], v[76:79], v[52:55], v[88:91]
    v_mfma_f32_16x16x32_bf16 v[160:163], v[76:79], v[56:59], v[160:163]
    v_mfma_f32_16x16x32_bf16 v[164:167], v[92:95], v[44:47], v[164:167]
    v_mfma_f32_16x16x32_bf16 v[168:171], v[92:95], v[48:51], v[168:171]
    v_mfma_f32_16x16x32_bf16 v[172:175], v[92:95], v[52:55], v[172:175]
    v_mfma_f32_16x16x32_bf16 v[176:179], v[92:95], v[56:59], v[176:179]
    v_mfma_f32_16x16x32_bf16 v[180:183], v[96:99], v[44:47], v[180:183]
    v_mfma_f32_16x16x32_bf16 v[184:187], v[96:99], v[48:51], v[184:187]
    v_mfma_f32_16x16x32_bf16 v[188:191], v[96:99], v[52:55], v[188:191]
    v_mfma_f32_16x16x32_bf16 v[220:223], v[96:99], v[56:59], v[220:223]
    v_mfma_f32_16x16x32_bf16 v[224:227], v[100:103], v[44:47], v[224:227]
    v_mfma_f32_16x16x32_bf16 v[228:231], v[100:103], v[48:51], v[228:231]
    v_mfma_f32_16x16x32_bf16 v[232:235], v[100:103], v[52:55], v[232:235]
    v_mfma_f32_16x16x32_bf16 v[236:239], v[100:103], v[56:59], v[236:239]
    v_mfma_f32_16x16x32_bf16 v[240:243], v[104:107], v[44:47], v[240:243]
    v_mfma_f32_16x16x32_bf16 v[244:247], v[104:107], v[48:51], v[244:247]
    v_mfma_f32_16x16x32_bf16 v[248:251], v[104:107], v[52:55], v[248:251]
    v_mfma_f32_16x16x32_bf16 v[252:255], v[104:107], v[56:59], v[252:255]
    s_waitcnt vmcnt(0) lgkmcnt(1)
    v_mfma_f32_16x16x32_bf16 v[84:87], v[108:111], v[64:67], v[84:87]
    v_mfma_f32_16x16x32_bf16 v[168:171], v[112:115], v[64:67], v[168:171]
    v_mfma_f32_16x16x32_bf16 v[184:187], v[116:119], v[64:67], v[184:187]
    v_mfma_f32_16x16x32_bf16 v[228:231], v[120:123], v[64:67], v[228:231]
    v_mfma_f32_16x16x32_bf16 v[244:247], v[124:127], v[64:67], v[244:247]
    v_mfma_f32_16x16x32_bf16 v[88:91], v[108:111], v[68:71], v[88:91]
    v_mfma_f32_16x16x32_bf16 v[172:175], v[112:115], v[68:71], v[172:175]
    v_mfma_f32_16x16x32_bf16 v[188:191], v[116:119], v[68:71], v[188:191]
    v_mfma_f32_16x16x32_bf16 v[232:235], v[120:123], v[68:71], v[232:235]
    ds_write_b128 v27, v[84:87] offset:0
    v_mfma_f32_16x16x32_bf16 v[248:251], v[124:127], v[68:71], v[248:251]
    ds_write_b128 v27, v[168:171] offset:1024
    v_mfma_f32_16x16x32_bf16 v[160:163], v[108:111], v[72:75], v[160:163]
    ds_write_b128 v27, v[184:187] offset:2048
    v_mfma_f32_16x16x32_bf16 v[176:179], v[112:115], v[72:75], v[176:179]
    ds_write_b128 v27, v[228:231] offset:3072
    v_mfma_f32_16x16x32_bf16 v[220:223], v[116:119], v[72:75], v[220:223]
    ds_write_b128 v27, v[244:247] offset:4096
    v_mfma_f32_16x16x32_bf16 v[236:239], v[120:123], v[72:75], v[236:239]
    ds_write_b128 v27, v[88:91] offset:5120
    v_mfma_f32_16x16x32_bf16 v[252:255], v[124:127], v[72:75], v[252:255]
    ds_write_b128 v27, v[172:175] offset:6144
    v_mfma_f32_16x16x32_bf16 v[80:83], v[108:111], v[60:63], v[80:83]
    ds_write_b128 v27, v[188:191] offset:7168
    v_mfma_f32_16x16x32_bf16 v[164:167], v[112:115], v[60:63], v[164:167]
    ds_write_b128 v27, v[232:235] offset:8192
    v_mfma_f32_16x16x32_bf16 v[180:183], v[116:119], v[60:63], v[180:183]
    ds_write_b128 v27, v[248:251] offset:9216
    v_mfma_f32_16x16x32_bf16 v[224:227], v[120:123], v[60:63], v[224:227]
    ds_write_b128 v27, v[160:163] offset:10240
    v_mfma_f32_16x16x32_bf16 v[240:243], v[124:127], v[60:63], v[240:243]
    ds_write_b128 v27, v[176:179] offset:11264
    ds_write_b128 v27, v[220:223] offset:12288
    ds_write_b128 v27, v[236:239] offset:13312
    ds_write_b128 v27, v[252:255] offset:14336
    ds_read_b64 v[200:201], v1 offset:0
    ds_read_b64 v[202:203], v1 offset:32
    ds_read_b64 v[216:217], v1 offset:64
    ds_read_b64 v[218:219], v1 offset:96
    ds_read_b64 v[140:141], v1 offset:128
    v_add_u32 v53, 86016, v24
    v_add_u32 v54, 70656, v24
    v_add_u32 v55, 10240, v24
    v_mov_b32 v76, v80
    v_mov_b32 v77, v81
    v_mov_b32 v78, v82
    v_mov_b32 v79, v83
    v_mov_b32 v92, v164
    v_mov_b32 v93, v165
    v_mov_b32 v94, v166
    v_mov_b32 v95, v167
    v_mov_b32 v96, v180
    v_mov_b32 v97, v181
    v_mov_b32 v98, v182
    v_mov_b32 v99, v183
    v_mov_b32 v100, v224
    v_mov_b32 v101, v225
    v_mov_b32 v102, v226
    v_mov_b32 v103, v227
    v_mov_b32 v104, v240
    v_mov_b32 v105, v241
    v_mov_b32 v106, v242
    v_mov_b32 v107, v243
    s_branch L_G2R
L_G2B:
    s_waitcnt vmcnt(12)
    v_mfma_f32_16x16x32_bf16 v[80:83], v[76:79], v[8:11], 0
    v_mfma_f32_16x16x32_bf16 v[84:87], v[76:79], v[12:15], 0
    v_mfma_f32_16x16x32_bf16 v[88:91], v[76:79], v[16:19], 0
    v_mfma_f32_16x16x32_bf16 v[160:163], v[76:79], v[20:23], 0
    v_mfma_f32_16x16x32_bf16 v[164:167], v[92:95], v[8:11], 0
    v_mfma_f32_16x16x32_bf16 v[168:171], v[92:95], v[12:15], 0
    v_mfma_f32_16x16x32_bf16 v[172:175], v[92:95], v[16:19], 0
    v_mfma_f32_16x16x32_bf16 v[176:179], v[92:95], v[20:23], 0
    v_mfma_f32_16x16x32_bf16 v[180:183], v[96:99], v[8:11], 0
    v_mfma_f32_16x16x32_bf16 v[184:187], v[96:99], v[12:15], 0
    v_mfma_f32_16x16x32_bf16 v[188:191], v[96:99], v[16:19], 0
    v_mfma_f32_16x16x32_bf16 v[220:223], v[96:99], v[20:23], 0
    v_mfma_f32_16x16x32_bf16 v[224:227], v[100:103], v[8:11], 0
    v_mfma_f32_16x16x32_bf16 v[228:231], v[100:103], v[12:15], 0
    v_mfma_f32_16x16x32_bf16 v[232:235], v[100:103], v[16:19], 0
    v_mfma_f32_16x16x32_bf16 v[236:239], v[100:103], v[20:23], 0
    v_mfma_f32_16x16x32_bf16 v[240:243], v[104:107], v[8:11], 0
    v_mfma_f32_16x16x32_bf16 v[244:247], v[104:107], v[12:15], 0
    v_mfma_f32_16x16x32_bf16 v[248:251], v[104:107], v[16:19], 0
    v_mfma_f32_16x16x32_bf16 v[252:255], v[104:107], v[20:23], 0
    s_waitcnt vmcnt(8)
    v_mfma_f32_16x16x32_bf16 v[80:83], v[108:111], v[28:31], v[80:83]
    s_cmp_eq_u32 s86, 4
    s_cselect_b32 s91, s89, 8192
    s_add_u32 s81, s81, s91
    buffer_load_dwordx4 v[8:11], v24, s[44:47], s81 offen offset:0 sc1
    v_mfma_f32_16x16x32_bf16 v[84:87], v[108:111], v[32:35], v[84:87]
    v_mfma_f32_16x16x32_bf16 v[88:91], v[108:111], v[36:39], v[88:91]
    buffer_load_dwordx4 v[12:15], v24, s[44:47], s81 offen offset:1024 sc1
    v_mfma_f32_16x16x32_bf16 v[160:163], v[108:111], v[40:43], v[160:163]
    v_mfma_f32_16x16x32_bf16 v[164:167], v[112:115], v[28:31], v[164:167]
    buffer_load_dwordx4 v[16:19], v24, s[44:47], s81 offen offset:2048 sc1
    v_mfma_f32_16x16x32_bf16 v[168:171], v[112:115], v[32:35], v[168:171]
    v_mfma_f32_16x16x32_bf16 v[172:175], v[112:115], v[36:39], v[172:175]
    buffer_load_dwordx4 v[20:23], v24, s[44:47], s81 offen offset:3072 sc1
    v_mfma_f32_16x16x32_bf16 v[176:179], v[112:115], v[40:43], v[176:179]
    v_mfma_f32_16x16x32_bf16 v[180:183], v[116:119], v[28:31], v[180:183]
    s_cmp_eq_u32 s86, 5
    s_cselect_b32 s91, s90, 10240
    s_add_u32 s82, s82, s91
    buffer_load_dwordx4 v[76:79], v24, s[44:47], s82 offen offset:0 sc1
    v_mfma_f32_16x16x32_bf16 v[184:187], v[116:119], v[32:35], v[184:187]
    v_mfma_f32_16x16x32_bf16 v[188:191], v[116:119], v[36:39], v[188:191]
    buffer_load_dwordx4 v[92:95], v24, s[44:47], s82 offen offset:1024 sc1
    v_mfma_f32_16x16x32_bf16 v[220:223], v[116:119], v[40:43], v[220:223]
    v_mfma_f32_16x16x32_bf16 v[224:227], v[120:123], v[28:31], v[224:227]
    buffer_load_dwordx4 v[96:99], v24, s[44:47], s82 offen offset:2048 sc1
    v_mfma_f32_16x16x32_bf16 v[228:231], v[120:123], v[32:35], v[228:231]
    v_mfma_f32_16x16x32_bf16 v[232:235], v[120:123], v[36:39], v[232:235]
    buffer_load_dwordx4 v[100:103], v24, s[44:47], s82 offen offset:3072 sc1
    v_mfma_f32_16x16x32_bf16 v[236:239], v[120:123], v[40:43], v[236:239]
    v_mfma_f32_16x16x32_bf16 v[240:243], v[124:127], v[28:31], v[240:243]
    buffer_load_dwordx4 v[104:107], v26, s[44:47], s82 offen offset:3072 sc1
    v_mfma_f32_16x16x32_bf16 v[244:247], v[124:127], v[32:35], v[244:247]
    v_mfma_f32_16x16x32_bf16 v[248:251], v[124:127], v[36:39], v[248:251]
    v_mfma_f32_16x16x32_bf16 v[252:255], v[124:127], v[40:43], v[252:255]
    s_waitcnt vmcnt(13)
    v_mfma_f32_16x16x32_bf16 v[80:83], v[128:131], v[44:47], v[80:83]
    s_cmp_eq_u32 s86, 5
    s_cselect_b32 s91, s89, 8192
    s_add_u32 s81, s81, s91
    buffer_load_dwordx4 v[28:31], v24, s[44:47], s81 offen offset:0 sc1
    v_mfma_f32_16x16x32_bf16 v[84:87], v[128:131], v[48:51], v[84:87]
    v_mfma_f32_16x16x32_bf16 v[88:91], v[128:131], v[52:55], v[88:91]
    buffer_load_dwordx4 v[32:35], v24, s[44:47], s81 offen offset:1024 sc1
    v_mfma_f32_16x16x32_bf16 v[160:163], v[128:131], v[56:59], v[160:163]
    v_mfma_f32_16x16x32_bf16 v[164:167], v[144:147], v[44:47], v[164:167]
    buffer_load_dwordx4 v[36:39], v24, s[44:47], s81 offen offset:2048 sc1
    v_mfma_f32_16x16x32_bf16 v[168:171], v[144:147], v[48:51], v[168:171]
    v_mfma_f32_16x16x32_bf16 v[172:175], v[144:147], v[52:55], v[172:175]
    buffer_load_dwordx4 v[40:43], v24, s[44:47], s81 offen offset:3072 sc1
    v_mfma_f32_16x16x32_bf16 v[176:179], v[144:147], v[56:59], v[176:179]
    v_mfma_f32_16x16x32_bf16 v[180:183], v[192:195], v[44:47], v[180:183]
    s_cmp_eq_u32 s86, 6
    s_cselect_b32 s91, s90, 10240
    s_add_u32 s82, s82, s91
    buffer_load_dwordx4 v[108:111], v24, s[44:47], s82 offen offset:0 sc1
    v_mfma_f32_16x16x32_bf16 v[184:187], v[192:195], v[48:51], v[184:187]
    v_mfma_f32_16x16x32_bf16 v[188:191], v[192:195], v[52:55], v[188:191]
    buffer_load_dwordx4 v[112:115], v24, s[44:47], s82 offen offset:1024 sc1
    v_mfma_f32_16x16x32_bf16 v[220:223], v[192:195], v[56:59], v[220:223]
    v_mfma_f32_16x16x32_bf16 v[224:227], v[208:211], v[44:47], v[224:227]
    buffer_load_dwordx4 v[116:119], v24, s[44:47], s82 offen offset:2048 sc1
    v_mfma_f32_16x16x32_bf16 v[228:231], v[208:211], v[48:51], v[228:231]
    v_mfma_f32_16x16x32_bf16 v[232:235], v[208:211], v[52:55], v[232:235]
    buffer_load_dwordx4 v[120:123], v24, s[44:47], s82 offen offset:3072 sc1
    v_mfma_f32_16x16x32_bf16 v[236:239], v[208:211], v[56:59], v[236:239]
    v_mfma_f32_16x16x32_bf16 v[240:243], v[132:135], v[44:47], v[240:243]
    buffer_load_dwordx4 v[124:127], v26, s[44:47], s82 offen offset:3072 sc1
    v_mfma_f32_16x16x32_bf16 v[244:247], v[132:135], v[48:51], v[244:247]
    v_mfma_f32_16x16x32_bf16 v[248:251], v[132:135], v[52:55], v[248:251]
    v_mfma_f32_16x16x32_bf16 v[252:255], v[132:135], v[56:59], v[252:255]
    s_waitcnt vmcnt(18)
    v_mfma_f32_16x16x32_bf16 v[80:83], v[148:151], v[60:63], v[80:83]
    s_cmp_eq_u32 s86, 6
    s_cselect_b32 s91, s89, 8192
    s_add_u32 s81, s81, s91
    buffer_load_dwordx4 v[44:47], v24, s[44:47], s81 offen offset:0 sc1
    v_mfma_f32_16x16x32_bf16 v[84:87], v[148:151], v[64:67], v[84:87]
    v_mfma_f32_16x16x32_bf16 v[88:91], v[148:151], v[68:71], v[88:91]
    buffer_load_dwordx4 v[48:51], v24, s[44:47], s81 offen offset:1024 sc1
    v_mfma_f32_16x16x32_bf16 v[160:163], v[148:151], v[72:75], v[160:163]
    v_mfma_f32_16x16x32_bf16 v[164:167], v[196:199], v[60:63], v[164:167]
    buffer_load_dwordx4 v[52:55], v24, s[44:47], s81 offen offset:2048 sc1
    v_mfma_f32_16x16x32_bf16 v[168:171], v[196:199], v[64:67], v[168:171]
    v_mfma_f32_16x16x32_bf16 v[172:175], v[196:199], v[68:71], v[172:175]
    buffer_load_dwordx4 v[56:59], v24, s[44:47], s81 offen offset:3072 sc1
    v_mfma_f32_16x16x32_bf16 v[176:179], v[196:199], v[72:75], v[176:179]
    v_mfma_f32_16x16x32_bf16 v[180:183], v[212:215], v[60:63], v[180:183]
    s_cmp_eq_u32 s86, 7
    s_cselect_b32 s91, s90, 10240
    s_add_u32 s82, s82, s91
    buffer_load_dwordx4 v[128:131], v24, s[44:47], s82 offen offset:0 sc1
    v_mfma_f32_16x16x32_bf16 v[184:187], v[212:215], v[64:67], v[184:187]
    v_mfma_f32_16x16x32_bf16 v[188:191], v[212:215], v[68:71], v[188:191]
    buffer_load_dwordx4 v[144:147], v24, s[44:47], s82 offen offset:1024 sc1
    v_mfma_f32_16x16x32_bf16 v[220:223], v[212:215], v[72:75], v[220:223]
    v_mfma_f32_16x16x32_bf16 v[224:227], v[136:139], v[60:63], v[224:227]
    buffer_load_dwordx4 v[192:195], v24, s[44:47], s82 offen offset:2048 sc1
    v_mfma_f32_16x16x32_bf16 v[228:231], v[136:139], v[64:67], v[228:231]
    v_mfma_f32_16x16x32_bf16 v[232:235], v[136:139], v[68:71], v[232:235]
    buffer_load_dwordx4 v[208:211], v24, s[44:47], s82 offen offset:3072 sc1
    v_mfma_f32_16x16x32_bf16 v[236:239], v[136:139], v[72:75], v[236:239]
    v_mfma_f32_16x16x32_bf16 v[240:243], v[152:155], v[60:63], v[240:243]
    buffer_load_dwordx4 v[132:135], v26, s[44:47], s82 offen offset:3072 sc1
    v_mfma_f32_16x16x32_bf16 v[244:247], v[152:155], v[64:67], v[244:247]
    v_mfma_f32_16x16x32_bf16 v[248:251], v[152:155], v[68:71], v[248:251]
    v_mfma_f32_16x16x32_bf16 v[252:255], v[152:155], v[72:75], v[252:255]
    s_waitcnt vmcnt(23)
    v_mov_b32 v4, 163160
    s_mov_b32 s73, 200000
LW_23:
    ds_read_b32 v5, v4
    s_waitcnt lgkmcnt(0)
    v_readfirstlane_b32 s72, v5
    s_nop 1
    s_cmp_ge_u32 s72, 2
    s_cbranch_scc1 LWD_24
    s_sub_u32 s73, s73, 1
    s_cmp_eq_u32 s73, 0
    s_cbranch_scc1 LWD_24
    s_sleep 0
    s_branch LW_23
LWD_24:
    v_mfma_f32_16x16x32_bf16 v[80:83], v[200:203], v[8:11], v[80:83]
    s_cmp_eq_u32 s86, 7
    s_cselect_b32 s91, s89, 8192
    s_add_u32 s81, s81, s91
    buffer_load_dwordx4 v[60:63], v24, s[44:47], s81 offen offset:0 sc1
    v_mfma_f32_16x16x32_bf16 v[84:87], v[200:203], v[12:15], v[84:87]
    v_mfma_f32_16x16x32_bf16 v[88:91], v[200:203], v[16:19], v[88:91]
    buffer_load_dwordx4 v[64:67], v24, s[44:47], s81 offen offset:1024 sc1
    v_mfma_f32_16x16x32_bf16 v[160:163], v[200:203], v[20:23], v[160:163]
    v_mfma_f32_16x16x32_bf16 v[164:167], v[216:219], v[8:11], v[164:167]
    buffer_load_dwordx4 v[68:71], v24, s[44:47], s81 offen offset:2048 sc1
    v_mfma_f32_16x16x32_bf16 v[168:171], v[216:219], v[12:15], v[168:171]
    v_mfma_f32_16x16x32_bf16 v[172:175], v[216:219], v[16:19], v[172:175]
    buffer_load_dwordx4 v[72:75], v24, s[44:47], s81 offen offset:3072 sc1
    v_mfma_f32_16x16x32_bf16 v[176:179], v[216:219], v[20:23], v[176:179]
    v_mfma_f32_16x16x32_bf16 v[180:183], v[140:143], v[8:11], v[180:183]
    s_cmp_eq_u32 s86, 8
    s_cselect_b32 s91, s90, 10240
    s_add_u32 s82, s82, s91
    buffer_load_dwordx4 v[148:151], v24, s[44:47], s82 offen offset:0 sc1
    v_mfma_f32_16x16x32_bf16 v[184:187], v[140:143], v[12:15], v[184:187]
    v_mfma_f32_16x16x32_bf16 v[188:191], v[140:143], v[16:19], v[188:191]
    buffer_load_dwordx4 v[196:199], v24, s[44:47], s82 offen offset:1024 sc1
    v_mfma_f32_16x16x32_bf16 v[220:223], v[140:143], v[20:23], v[220:223]
    v_mfma_f32_16x16x32_bf16 v[224:227], v[156:159], v[8:11], v[224:227]
    buffer_load_dwordx4 v[212:215], v24, s[44:47], s82 offen offset:2048 sc1
    v_mfma_f32_16x16x32_bf16 v[228:231], v[156:159], v[12:15], v[228:231]
    v_mfma_f32_16x16x32_bf16 v[232:235], v[156:159], v[16:19], v[232:235]
    buffer_load_dwordx4 v[136:139], v24, s[44:47], s82 offen offset:3072 sc1
    v_mfma_f32_16x16x32_bf16 v[236:239], v[156:159], v[20:23], v[236:239]
    v_mfma_f32_16x16x32_bf16 v[240:243], v[204:207], v[8:11], v[240:243]
    buffer_load_dwordx4 v[152:155], v26, s[44:47], s82 offen offset:3072 sc1
    v_mfma_f32_16x16x32_bf16 v[244:247], v[204:207], v[12:15], v[244:247]
    v_mfma_f32_16x16x32_bf16 v[248:251], v[204:207], v[16:19], v[248:251]
    v_mfma_f32_16x16x32_bf16 v[252:255], v[204:207], v[20:23], v[252:255]
    s_waitcnt vmcnt(23)
    v_mfma_f32_16x16x32_bf16 v[80:83], v[76:79], v[28:31], v[80:83]
    s_cmp_eq_u32 s86, 8
    s_cselect_b32 s91, s89, 8192
    s_add_u32 s81, s81, s91
    buffer_load_dwordx4 v[8:11], v24, s[44:47], s81 offen offset:0 sc1
    v_mfma_f32_16x16x32_bf16 v[84:87], v[76:79], v[32:35], v[84:87]
    v_mfma_f32_16x16x32_bf16 v[88:91], v[76:79], v[36:39], v[88:91]
    buffer_load_dwordx4 v[12:15], v24, s[44:47], s81 offen offset:1024 sc1
    v_mfma_f32_16x16x32_bf16 v[160:163], v[76:79], v[40:43], v[160:163]
    v_mfma_f32_16x16x32_bf16 v[164:167], v[92:95], v[28:31], v[164:167]
    buffer_load_dwordx4 v[16:19], v24, s[44:47], s81 offen offset:2048 sc1
    v_mfma_f32_16x16x32_bf16 v[168:171], v[92:95], v[32:35], v[168:171]
    v_mfma_f32_16x16x32_bf16 v[172:175], v[92:95], v[36:39], v[172:175]
    buffer_load_dwordx4 v[20:23], v24, s[44:47], s81 offen offset:3072 sc1
    v_mfma_f32_16x16x32_bf16 v[176:179], v[92:95], v[40:43], v[176:179]
    v_mfma_f32_16x16x32_bf16 v[180:183], v[96:99], v[28:31], v[180:183]
    s_cmp_eq_u32 s86, 9
    s_cselect_b32 s91, s90, 10240
    s_add_u32 s82, s82, s91
    buffer_load_dwordx4 v[200:203], v24, s[44:47], s82 offen offset:0 sc1
    v_mfma_f32_16x16x32_bf16 v[184:187], v[96:99], v[32:35], v[184:187]
    v_mfma_f32_16x16x32_bf16 v[188:191], v[96:99], v[36:39], v[188:191]
    buffer_load_dwordx4 v[216:219], v24, s[44:47], s82 offen offset:1024 sc1
    v_mfma_f32_16x16x32_bf16 v[220:223], v[96:99], v[40:43], v[220:223]
    v_mfma_f32_16x16x32_bf16 v[224:227], v[100:103], v[28:31], v[224:227]
    buffer_load_dwordx4 v[140:143], v24, s[44:47], s82 offen offset:2048 sc1
    v_mfma_f32_16x16x32_bf16 v[228:231], v[100:103], v[32:35], v[228:231]
    v_mfma_f32_16x16x32_bf16 v[232:235], v[100:103], v[36:39], v[232:235]
    buffer_load_dwordx4 v[156:159], v24, s[44:47], s82 offen offset:3072 sc1
    v_mfma_f32_16x16x32_bf16 v[236:239], v[100:103], v[40:43], v[236:239]
    v_mfma_f32_16x16x32_bf16 v[240:243], v[104:107], v[28:31], v[240:243]
    buffer_load_dwordx4 v[204:207], v26, s[44:47], s82 offen offset:3072 sc1
    v_mfma_f32_16x16x32_bf16 v[244:247], v[104:107], v[32:35], v[244:247]
    v_mfma_f32_16x16x32_bf16 v[248:251], v[104:107], v[36:39], v[248:251]
    v_mfma_f32_16x16x32_bf16 v[252:255], v[104:107], v[40:43], v[252:255]
    s_waitcnt vmcnt(23)
    v_mov_b32 v4, 163232
    s_mov_b32 s73, 200000
LW_25:
    ds_read_b32 v5, v4
    s_waitcnt lgkmcnt(0)
    v_readfirstlane_b32 s72, v5
    s_nop 1
    s_cmp_ge_u32 s72, 1
    s_cbranch_scc1 LWD_26
    s_sub_u32 s73, s73, 1
    s_cmp_eq_u32 s73, 0
    s_cbranch_scc1 LWD_26
    s_sleep 1
    s_branch LW_25
LWD_26:
    v_mfma_f32_16x16x32_bf16 v[80:83], v[108:111], v[44:47], v[80:83]
    s_cmp_eq_u32 s86, 9
    s_cselect_b32 s91, s89, 8192
    s_add_u32 s81, s81, s91
    buffer_load_dwordx4 v[28:31], v24, s[44:47], s81 offen offset:0 sc1
    v_mfma_f32_16x16x32_bf16 v[84:87], v[108:111], v[48:51], v[84:87]
    v_mfma_f32_16x16x32_bf16 v[88:91], v[108:111], v[52:55], v[88:91]
    buffer_load_dwordx4 v[32:35], v24, s[44:47], s81 offen offset:1024 sc1
    v_mfma_f32_16x16x32_bf16 v[160:163], v[108:111], v[56:59], v[160:163]
    v_mfma_f32_16x16x32_bf16 v[164:167], v[112:115], v[44:47], v[164:167]
    buffer_load_dwordx4 v[36:39], v24, s[44:47], s81 offen offset:2048 sc1
    v_mfma_f32_16x16x32_bf16 v[168:171], v[112:115], v[48:51], v[168:171]
    v_mfma_f32_16x16x32_bf16 v[172:175], v[112:115], v[52:55], v[172:175]
    buffer_load_dwordx4 v[40:43], v24, s[44:47], s81 offen offset:3072 sc1
    v_mfma_f32_16x16x32_bf16 v[176:179], v[112:115], v[56:59], v[176:179]
    v_mfma_f32_16x16x32_bf16 v[180:183], v[116:119], v[44:47], v[180:183]
    ds_read_b128 v[76:79], v27 offset:0
    v_mfma_f32_16x16x32_bf16 v[184:187], v[116:119], v[48:51], v[184:187]
    v_mfma_f32_16x16x32_bf16 v[188:191], v[116:119], v[52:55], v[188:191]
    ds_read_b128 v[92:95], v27 offset:1024
    v_mfma_f32_16x16x32_bf16 v[220:223], v[116:119], v[56:59], v[220:223]
    v_mfma_f32_16x16x32_bf16 v[224:227], v[120:123], v[44:47], v[224:227]
    ds_read_b128 v[96:99], v27 offset:2048
    v_mfma_f32_16x16x32_bf16 v[228:231], v[120:123], v[48:51], v[228:231]
    v_mfma_f32_16x16x32_bf16 v[232:235], v[120:123], v[52:55], v[232:235]
    ds_read_b128 v[100:103], v27 offset:3072
    v_mfma_f32_16x16x32_bf16 v[236:239], v[120:123], v[56:59], v[236:239]
    v_mfma_f32_16x16x32_bf16 v[240:243], v[124:127], v[44:47], v[240:243]
    ds_read_b128 v[104:107], v27 offset:4096
    v_mfma_f32_16x16x32_bf16 v[244:247], v[124:127], v[48:51], v[244:247]
    v_mfma_f32_16x16x32_bf16 v[248:251], v[124:127], v[52:55], v[248:251]
    v_mfma_f32_16x16x32_bf16 v[252:255], v[124:127], v[56:59], v[252:255]
    s_waitcnt vmcnt(18)
    v_mfma_f32_16x16x32_bf16 v[80:83], v[128:131], v[60:63], v[80:83]
    s_cmp_eq_u32 s86, 10
    s_cselect_b32 s91, s89, 8192
    s_add_u32 s81, s81, s91
    buffer_load_dwordx4 v[44:47], v24, s[44:47], s81 offen offset:0 sc1
    v_mfma_f32_16x16x32_bf16 v[84:87], v[128:131], v[64:67], v[84:87]
    v_mfma_f32_16x16x32_bf16 v[88:91], v[128:131], v[68:71], v[88:91]
    buffer_load_dwordx4 v[48:51], v24, s[44:47], s81 offen offset:1024 sc1
    v_mfma_f32_16x16x32_bf16 v[160:163], v[128:131], v[72:75], v[160:163]
    v_mfma_f32_16x16x32_bf16 v[164:167], v[144:147], v[60:63], v[164:167]
    buffer_load_dwordx4 v[52:55], v24, s[44:47], s81 offen offset:2048 sc1
    v_mfma_f32_16x16x32_bf16 v[168:171], v[144:147], v[64:67], v[168:171]
    v_mfma_f32_16x16x32_bf16 v[172:175], v[144:147], v[68:71], v[172:175]
    buffer_load_dwordx4 v[56:59], v24, s[44:47], s81 offen offset:3072 sc1
    v_mfma_f32_16x16x32_bf16 v[176:179], v[144:147], v[72:75], v[176:179]
    v_mfma_f32_16x16x32_bf16 v[180:183], v[192:195], v[60:63], v[180:183]
    ds_read_b128 v[108:111], v27 offset:5120
    v_mfma_f32_16x16x32_bf16 v[184:187], v[192:195], v[64:67], v[184:187]
    v_mfma_f32_16x16x32_bf16 v[188:191], v[192:195], v[68:71], v[188:191]
    ds_read_b128 v[112:115], v27 offset:6144
    v_mfma_f32_16x16x32_bf16 v[220:223], v[192:195], v[72:75], v[220:223]
    v_mfma_f32_16x16x32_bf16 v[224:227], v[208:211], v[60:63], v[224:227]
    ds_read_b128 v[116:119], v27 offset:7168
    v_mfma_f32_16x16x32_bf16 v[228:231], v[208:211], v[64:67], v[228:231]
    v_mfma_f32_16x16x32_bf16 v[232:235], v[208:211], v[68:71], v[232:235]
    ds_read_b128 v[120:123], v27 offset:8192
    v_mfma_f32_16x16x32_bf16 v[236:239], v[208:211], v[72:75], v[236:239]
    v_mfma_f32_16x16x32_bf16 v[240:243], v[132:135], v[60:63], v[240:243]
    ds_read_b128 v[124:127], v27 offset:9216
    v_mfma_f32_16x16x32_bf16 v[244:247], v[132:135], v[64:67], v[244:247]
    v_mfma_f32_16x16x32_bf16 v[248:251], v[132:135], v[68:71], v[248:251]
    v_mfma_f32_16x16x32_bf16 v[252:255], v[132:135], v[72:75], v[252:255]
    s_waitcnt vmcnt(13)
    v_mfma_f32_16x16x32_bf16 v[80:83], v[148:151], v[8:11], v[80:83]
    s_cmp_eq_u32 s86, 11
    s_cselect_b32 s91, s89, 8192
    s_add_u32 s81, s81, s91
    buffer_load_dwordx4 v[60:63], v24, s[44:47], s81 offen offset:0 sc1
    v_mfma_f32_16x16x32_bf16 v[84:87], v[148:151], v[12:15], v[84:87]
    v_mfma_f32_16x16x32_bf16 v[88:91], v[148:151], v[16:19], v[88:91]
    buffer_load_dwordx4 v[64:67], v24, s[44:47], s81 offen offset:1024 sc1
    v_mfma_f32_16x16x32_bf16 v[160:163], v[148:151], v[20:23], v[160:163]
    v_mfma_f32_16x16x32_bf16 v[164:167], v[196:199], v[8:11], v[164:167]
    buffer_load_dwordx4 v[68:71], v24, s[44:47], s81 offen offset:2048 sc1
    v_mfma_f32_16x16x32_bf16 v[168:171], v[196:199], v[12:15], v[168:171]
    v_mfma_f32_16x16x32_bf16 v[172:175], v[196:199], v[16:19], v[172:175]
    buffer_load_dwordx4 v[72:75], v24, s[44:47], s81 offen offset:3072 sc1
    v_mfma_f32_16x16x32_bf16 v[176:179], v[196:199], v[20:23], v[176:179]
    v_mfma_f32_16x16x32_bf16 v[180:183], v[212:215], v[8:11], v[180:183]
    ds_read_b128 v[128:131], v27 offset:10240
    v_mfma_f32_16x16x32_bf16 v[184:187], v[212:215], v[12:15], v[184:187]
    v_mfma_f32_16x16x32_bf16 v[188:191], v[212:215], v[16:19], v[188:191]
    ds_read_b128 v[144:147], v27 offset:11264
    v_mfma_f32_16x16x32_bf16 v[220:223], v[212:215], v[20:23], v[220:223]
    v_mfma_f32_16x16x32_bf16 v[224:227], v[136:139], v[8:11], v[224:227]
    ds_read_b128 v[192:195], v27 offset:12288
    v_mfma_f32_16x16x32_bf16 v[228:231], v[136:139], v[12:15], v[228:231]
    v_mfma_f32_16x16x32_bf16 v[232:235], v[136:139], v[16:19], v[232:235]
    ds_read_b128 v[208:211], v27 offset:13312
    v_mfma_f32_16x16x32_bf16 v[236:239], v[136:139], v[20:23], v[236:239]
    v_mfma_f32_16x16x32_bf16 v[240:243], v[152:155], v[8:11], v[240:243]
    ds_read_b128 v[132:135], v27 offset:14336
    v_mfma_f32_16x16x32_bf16 v[244:247], v[152:155], v[12:15], v[244:247]
    v_mfma_f32_16x16x32_bf16 v[248:251], v[152:155], v[16:19], v[248:251]
    v_mfma_f32_16x16x32_bf16 v[252:255], v[152:155], v[20:23], v[252:255]
    s_waitcnt vmcnt(8)
    v_mfma_f32_16x16x32_bf16 v[80:83], v[200:203], v[28:31], v[80:83]
    s_cmp_eq_u32 s86, 12
    s_cselect_b32 s91, s89, 8192
    s_add_u32 s81, s81, s91
    buffer_load_dwordx4 v[8:11], v24, s[44:47], s81 offen offset:0 sc1
    v_mfma_f32_16x16x32_bf16 v[84:87], v[200:203], v[32:35], v[84:87]
    v_mfma_f32_16x16x32_bf16 v[88:91], v[200:203], v[36:39], v[88:91]
    buffer_load_dwordx4 v[12:15], v24, s[44:47], s81 offen offset:1024 sc1
    v_mfma_f32_16x16x32_bf16 v[160:163], v[200:203], v[40:43], v[160:163]
    v_mfma_f32_16x16x32_bf16 v[164:167], v[216:219], v[28:31], v[164:167]
    buffer_load_dwordx4 v[16:19], v24, s[44:47], s81 offen offset:2048 sc1
    v_mfma_f32_16x16x32_bf16 v[168:171], v[216:219], v[32:35], v[168:171]
    v_mfma_f32_16x16x32_bf16 v[172:175], v[216:219], v[36:39], v[172:175]
    buffer_load_dwordx4 v[20:23], v24, s[44:47], s81 offen offset:3072 sc1
    v_mfma_f32_16x16x32_bf16 v[176:179], v[216:219], v[40:43], v[176:179]
    v_mfma_f32_16x16x32_bf16 v[180:183], v[140:143], v[28:31], v[180:183]
    ds_read_b128 v[148:151], v27 offset:15360
    v_mfma_f32_16x16x32_bf16 v[184:187], v[140:143], v[32:35], v[184:187]
    v_mfma_f32_16x16x32_bf16 v[188:191], v[140:143], v[36:39], v[188:191]
    ds_read_b128 v[196:199], v27 offset:16384
    v_mfma_f32_16x16x32_bf16 v[220:223], v[140:143], v[40:43], v[220:223]
    v_mfma_f32_16x16x32_bf16 v[224:227], v[156:159], v[28:31], v[224:227]
    ds_read_b128 v[212:215], v27 offset:17408
    v_mfma_f32_16x16x32_bf16 v[228:231], v[156:159], v[32:35], v[228:231]
    v_mfma_f32_16x16x32_bf16 v[232:235], v[156:159], v[36:39], v[232:235]
    ds_read_b128 v[136:139], v27 offset:18432
    v_mfma_f32_16x16x32_bf16 v[236:239], v[156:159], v[40:43], v[236:239]
    v_mfma_f32_16x16x32_bf16 v[240:243], v[204:207], v[28:31], v[240:243]
    ds_read_b128 v[152:155], v27 offset:19456
    v_mfma_f32_16x16x32_bf16 v[244:247], v[204:207], v[32:35], v[244:247]
    v_mfma_f32_16x16x32_bf16 v[248:251], v[204:207], v[36:39], v[248:251]
    v_mfma_f32_16x16x32_bf16 v[252:255], v[204:207], v[40:43], v[252:255]
    s_waitcnt vmcnt(8) lgkmcnt(15)
    v_mfma_f32_16x16x32_bf16 v[80:83], v[76:79], v[44:47], v[80:83]
    s_cmp_eq_u32 s86, 13
    s_cselect_b32 s91, s89, 8192
    s_add_u32 s81, s81, s91
    buffer_load_dwordx4 v[28:31], v24, s[44:47], s81 offen offset:0 sc1
    v_mfma_f32_16x16x32_bf16 v[84:87], v[76:79], v[48:51], v[84:87]
    v_mfma_f32_16x16x32_bf16 v[88:91], v[76:79], v[52:55], v[88:91]
    buffer_load_dwordx4 v[32:35], v24, s[44:47], s81 offen offset:1024 sc1
    v_mfma_f32_16x16x32_bf16 v[160:163], v[76:79], v[56:59], v[160:163]
    v_mfma_f32_16x16x32_bf16 v[164:167], v[92:95], v[44:47], v[164:167]
    buffer_load_dwordx4 v[36:39], v24, s[44:47], s81 offen offset:2048 sc1
    v_mfma_f32_16x16x32_bf16 v[168:171], v[92:95], v[48:51], v[168:171]
    v_mfma_f32_16x16x32_bf16 v[172:175], v[92:95], v[52:55], v[172:175]
    buffer_load_dwordx4 v[40:43], v24, s[44:47], s81 offen offset:3072 sc1
    v_mfma_f32_16x16x32_bf16 v[176:179], v[92:95], v[56:59], v[176:179]
    v_mfma_f32_16x16x32_bf16 v[180:183], v[96:99], v[44:47], v[180:183]
    s_lshl_b32 s72, s3, 2
    v_mov_b32 v4, 163248
    v_add_u32 v4, s72, v4
    v_mov_b32 v5, 1
    ds_write_b32 v4, v5
    v_mfma_f32_16x16x32_bf16 v[184:187], v[96:99], v[48:51], v[184:187]
    v_mfma_f32_16x16x32_bf16 v[188:191], v[96:99], v[52:55], v[188:191]
    v_mfma_f32_16x16x32_bf16 v[220:223], v[96:99], v[56:59], v[220:223]
    v_mfma_f32_16x16x32_bf16 v[224:227], v[100:103], v[44:47], v[224:227]
    v_mfma_f32_16x16x32_bf16 v[228:231], v[100:103], v[48:51], v[228:231]
    v_mfma_f32_16x16x32_bf16 v[232:235], v[100:103], v[52:55], v[232:235]
    v_mfma_f32_16x16x32_bf16 v[236:239], v[100:103], v[56:59], v[236:239]
    v_mfma_f32_16x16x32_bf16 v[240:243], v[104:107], v[44:47], v[240:243]
    v_mfma_f32_16x16x32_bf16 v[244:247], v[104:107], v[48:51], v[244:247]
    v_mfma_f32_16x16x32_bf16 v[248:251], v[104:107], v[52:55], v[248:251]
    v_mfma_f32_16x16x32_bf16 v[252:255], v[104:107], v[56:59], v[252:255]
    s_waitcnt vmcnt(8) lgkmcnt(11)
    v_mfma_f32_16x16x32_bf16 v[80:83], v[108:111], v[60:63], v[80:83]
    v_mfma_f32_16x16x32_bf16 v[84:87], v[108:111], v[64:67], v[84:87]
    v_mfma_f32_16x16x32_bf16 v[88:91], v[108:111], v[68:71], v[88:91]
    v_mfma_f32_16x16x32_bf16 v[160:163], v[108:111], v[72:75], v[160:163]
    v_mfma_f32_16x16x32_bf16 v[164:167], v[112:115], v[60:63], v[164:167]
    v_mfma_f32_16x16x32_bf16 v[168:171], v[112:115], v[64:67], v[168:171]
    v_mfma_f32_16x16x32_bf16 v[172:175], v[112:115], v[68:71], v[172:175]
    v_mfma_f32_16x16x32_bf16 v[176:179], v[112:115], v[72:75], v[176:179]
    v_mfma_f32_16x16x32_bf16 v[180:183], v[116:119], v[60:63], v[180:183]
    v_mfma_f32_16x16x32_bf16 v[184:187], v[116:119], v[64:67], v[184:187]
    v_mfma_f32_16x16x32_bf16 v[188:191], v[116:119], v[68:71], v[188:191]
    v_mfma_f32_16x16x32_bf16 v[220:223], v[116:119], v[72:75], v[220:223]
    v_mfma_f32_16x16x32_bf16 v[224:227], v[120:123], v[60:63], v[224:227]
    v_mfma_f32_16x16x32_bf16 v[228:231], v[120:123], v[64:67], v[228:231]
    v_mfma_f32_16x16x32_bf16 v[232:235], v[120:123], v[68:71], v[232:235]
    v_mfma_f32_16x16x32_bf16 v[236:239], v[120:123], v[72:75], v[236:239]
    v_mfma_f32_16x16x32_bf16 v[240:243], v[124:127], v[60:63], v[240:243]
    v_mfma_f32_16x16x32_bf16 v[244:247], v[124:127], v[64:67], v[244:247]
    v_mfma_f32_16x16x32_bf16 v[248:251], v[124:127], v[68:71], v[248:251]
    v_mfma_f32_16x16x32_bf16 v[252:255], v[124:127], v[72:75], v[252:255]
    s_waitcnt vmcnt(4) lgkmcnt(6)
    v_mfma_f32_16x16x32_bf16 v[80:83], v[128:131], v[8:11], v[80:83]
    v_mfma_f32_16x16x32_bf16 v[84:87], v[128:131], v[12:15], v[84:87]
    v_mfma_f32_16x16x32_bf16 v[88:91], v[128:131], v[16:19], v[88:91]
    v_mfma_f32_16x16x32_bf16 v[160:163], v[128:131], v[20:23], v[160:163]
    v_mfma_f32_16x16x32_bf16 v[164:167], v[144:147], v[8:11], v[164:167]
    v_mfma_f32_16x16x32_bf16 v[168:171], v[144:147], v[12:15], v[168:171]
    v_mfma_f32_16x16x32_bf16 v[172:175], v[144:147], v[16:19], v[172:175]
    v_mfma_f32_16x16x32_bf16 v[176:179], v[144:147], v[20:23], v[176:179]
    v_mfma_f32_16x16x32_bf16 v[180:183], v[192:195], v[8:11], v[180:183]
    v_mfma_f32_16x16x32_bf16 v[184:187], v[192:195], v[12:15], v[184:187]
    v_mfma_f32_16x16x32_bf16 v[188:191], v[192:195], v[16:19], v[188:191]
    v_mfma_f32_16x16x32_bf16 v[220:223], v[192:195], v[20:23], v[220:223]
    v_mfma_f32_16x16x32_bf16 v[224:227], v[208:211], v[8:11], v[224:227]
    v_mfma_f32_16x16x32_bf16 v[228:231], v[208:211], v[12:15], v[228:231]
    v_mfma_f32_16x16x32_bf16 v[232:235], v[208:211], v[16:19], v[232:235]
    v_mfma_f32_16x16x32_bf16 v[236:239], v[208:211], v[20:23], v[236:239]
    v_mfma_f32_16x16x32_bf16 v[240:243], v[132:135], v[8:11], v[240:243]
    v_mfma_f32_16x16x32_bf16 v[244:247], v[132:135], v[12:15], v[244:247]
    v_mfma_f32_16x16x32_bf16 v[248:251], v[132:135], v[16:19], v[248:251]
    v_mfma_f32_16x16x32_bf16 v[252:255], v[132:135], v[20:23], v[252:255]
    s_waitcnt vmcnt(0) lgkmcnt(1)
    s_cmp_lg_u32 s3, 1
    s_cbranch_scc1 L_G2W1
    v_mfma_f32_16x16x32_bf16 v[88:91], v[148:151], v[36:39], v[88:91]
    v_mfma_f32_16x16x32_bf16 v[172:175], v[196:199], v[36:39], v[172:175]
    v_mfma_f32_16x16x32_bf16 v[188:191], v[212:215], v[36:39], v[188:191]
    v_mfma_f32_16x16x32_bf16 v[232:235], v[136:139], v[36:39], v[232:235]
    v_mfma_f32_16x16x32_bf16 v[248:251], v[152:155], v[36:39], v[248:251]
    v_mfma_f32_16x16x32_bf16 v[160:163], v[148:151], v[40:43], v[160:163]
    v_mfma_f32_16x16x32_bf16 v[176:179], v[196:199], v[40:43], v[176:179]
    v_mfma_f32_16x16x32_bf16 v[220:223], v[212:215], v[40:43], v[220:223]
    v_mfma_f32_16x16x32_bf16 v[236:239], v[136:139], v[40:43], v[236:239]
    ds_write_b128 v27, v[88:91] offset:0
    v_mfma_f32_16x16x32_bf16 v[252:255], v[152:155], v[40:43], v[252:255]
    ds_write_b128 v27, v[172:175] offset:1024
    v_mfma_f32_16x16x32_bf16 v[80:83], v[148:151], v[28:31], v[80:83]
    ds_write_b128 v27, v[188:191] offset:2048
    v_mfma_f32_16x16x32_bf16 v[164:167], v[196:199], v[28:31], v[164:167]
    ds_write_b128 v27, v[232:235] offset:3072
    v_mfma_f32_16x16x32_bf16 v[180:183], v[212:215], v[28:31], v[180:183]
    ds_write_b128 v27, v[248:251] offset:4096
    v_mfma_f32_16x16x32_bf16 v[224:227], v[136:139], v[28:31], v[224:227]
    ds_write_b128 v27, v[160:163] offset:5120
    v_mfma_f32_16x16x32_bf16 v[240:243], v[152:155], v[28:31], v[240:243]
    ds_write_b128 v27, v[176:179] offset:6144
    v_mfma_f32_16x16x32_bf16 v[84:87], v[148:151], v[32:35], v[84:87]
    ds_write_b128 v27, v[220:223] offset:7168
    v_mfma_f32_16x16x32_bf16 v[168:171], v[196:199], v[32:35], v[168:171]
    ds_write_b128 v27, v[236:239] offset:8192
    v_mfma_f32_16x16x32_bf16 v[184:187], v[212:215], v[32:35], v[184:187]
    ds_write_b128 v27, v[252:255] offset:9216
    v_mfma_f32_16x16x32_bf16 v[228:231], v[136:139], v[32:35], v[228:231]
    ds_write_b128 v27, v[80:83] offset:10240
    v_mfma_f32_16x16x32_bf16 v[244:247], v[152:155], v[32:35], v[244:247]
    ds_write_b128 v27, v[164:167] offset:11264
    ds_write_b128 v27, v[180:183] offset:12288
    ds_write_b128 v27, v[224:227] offset:13312
    ds_write_b128 v27, v[240:243] offset:14336
    ds_read_b64 v[200:201], v1 offset:0
    ds_read_b64 v[202:203], v1 offset:32
    ds_read_b64 v[216:217], v1 offset:64
    ds_read_b64 v[218:219], v1 offset:96
    ds_read_b64 v[140:141], v1 offset:128
    v_add_u32 v53, 131072, v24
    v_add_u32 v54, 91136, v24
    v_add_u32 v55, 75776, v24
    v_mov_b32 v76, v84
    v_mov_b32 v77, v85
    v_mov_b32 v78, v86
    v_mov_b32 v79, v87
    v_mov_b32 v92, v168
    v_mov_b32 v93, v169
    v_mov_b32 v94, v170
    v_mov_b32 v95, v171
    v_mov_b32 v96, v184
    v_mov_b32 v97, v185
    v_mov_b32 v98, v186
    v_mov_b32 v99, v187
    v_mov_b32 v100, v228
    v_mov_b32 v101, v229
    v_mov_b32 v102, v230
    v_mov_b32 v103, v231
    v_mov_b32 v104, v244
    v_mov_b32 v105, v245
    v_mov_b32 v106, v246
    v_mov_b32 v107, v247
    s_branch L_G2R
L_G2W1:
    s_cmp_lg_u32 s3, 2
    s_cbranch_scc1 L_G2W2
    v_mfma_f32_16x16x32_bf16 v[160:163], v[148:151], v[40:43], v[160:163]
    v_mfma_f32_16x16x32_bf16 v[176:179], v[196:199], v[40:43], v[176:179]
    v_mfma_f32_16x16x32_bf16 v[220:223], v[212:215], v[40:43], v[220:223]
    v_mfma_f32_16x16x32_bf16 v[236:239], v[136:139], v[40:43], v[236:239]
    v_mfma_f32_16x16x32_bf16 v[252:255], v[152:155], v[40:43], v[252:255]
    v_mfma_f32_16x16x32_bf16 v[80:83], v[148:151], v[28:31], v[80:83]
    v_mfma_f32_16x16x32_bf16 v[164:167], v[196:199], v[28:31], v[164:167]
    v_mfma_f32_16x16x32_bf16 v[180:183], v[212:215], v[28:31], v[180:183]
    v_mfma_f32_16x16x32_bf16 v[224:227], v[136:139], v[28:31], v[224:227]
    ds_write_b128 v27, v[160:163] offset:0
    v_mfma_f32_16x16x32_bf16 v[240:243], v[152:155], v[28:31], v[240:243]
    ds_write_b128 v27, v[176:179] offset:1024
    v_mfma_f32_16x16x32_bf16 v[84:87], v[148:151], v[32:35], v[84:87]
    ds_write_b128 v27, v[220:223] offset:2048
    v_mfma_f32_16x16x32_bf16 v[168:171], v[196:199], v[32:35], v[168:171]
    ds_write_b128 v27, v[236:239] offset:3072
    v_mfma_f32_16x16x32_bf16 v[184:187], v[212:215], v[32:35], v[184:187]
    ds_write_b128 v27, v[252:255] offset:4096
    v_mfma_f32_16x16x32_bf16 v[228:231], v[136:139], v[32:35], v[228:231]
    ds_write_b128 v27, v[80:83] offset:5120
    v_mfma_f32_16x16x32_bf16 v[244:247], v[152:155], v[32:35], v[244:247]
    ds_write_b128 v27, v[164:167] offset:6144
    v_mfma_f32_16x16x32_bf16 v[88:91], v[148:151], v[36:39], v[88:91]
    ds_write_b128 v27, v[180:183] offset:7168
    v_mfma_f32_16x16x32_bf16 v[172:175], v[196:199], v[36:39], v[172:175]
    ds_write_b128 v27, v[224:227] offset:8192
    v_mfma_f32_16x16x32_bf16 v[188:191], v[212:215], v[36:39], v[188:191]
    ds_write_b128 v27, v[240:243] offset:9216
    v_mfma_f32_16x16x32_bf16 v[232:235], v[136:139], v[36:39], v[232:235]
    ds_write_b128 v27, v[84:87] offset:10240
    v_mfma_f32_16x16x32_bf16 v[248:251], v[152:155], v[36:39], v[248:251]
    ds_write_b128 v27, v[168:171] offset:11264
    ds_write_b128 v27, v[184:187] offset:12288
    ds_write_b128 v27, v[228:231] offset:13312
    ds_write_b128 v27, v[244:247] offset:14336
    ds_read_b64 v[200:201], v1 offset:0
    ds_read_b64 v[202:203], v1 offset:32
    ds_read_b64 v[216:217], v1 offset:64
    ds_read_b64 v[218:219], v1 offset:96
    ds_read_b64 v[140:141], v1 offset:128
    v_add_u32 v53, 0, v24
    v_add_u32 v54, 136192, v24
    v_add_u32 v55, 96256, v24
    v_mov_b32 v76, v88
    v_mov_b32 v77, v89
    v_mov_b32 v78, v90
    v_mov_b32 v79, v91
    v_mov_b32 v92, v172
    v_mov_b32 v93, v173
    v_mov_b32 v94, v174
    v_mov_b32 v95, v175
    v_mov_b32 v96, v188
    v_mov_b32 v97, v189
    v_mov_b32 v98, v190
    v_mov_b32 v99, v191
    v_mov_b32 v100, v232
    v_mov_b32 v101, v233
    v_mov_b32 v102, v234
    v_mov_b32 v103, v235
    v_mov_b32 v104, v248
    v_mov_b32 v105, v249
    v_mov_b32 v106, v250
    v_mov_b32 v107, v251
    s_branch L_G2R
L_G2W2:
    v_mfma_f32_16x16x32_bf16 v[80:83], v[148:151], v[28:31], v[80:83]
    v_mfma_f32_16x16x32_bf16 v[164:167], v[196:199], v[28:31], v[164:167]
    v_mfma_f32_16x16x32_bf16 v[180:183], v[212:215], v[28:31], v[180:183]
    v_mfma_f32_16x16x32_bf16 v[224:227], v[136:139], v[28:31], v[224:227]
    v_mfma_f32_16x16x32_bf16 v[240:243], v[152:155], v[28:31], v[240:243]
    v_mfma_f32_16x16x32_bf16 v[84:87], v[148:151], v[32:35], v[84:87]
    v_mfma_f32_16x16x32_bf16 v[168:171], v[196:199], v[32:35], v[168:171]
    v_mfma_f32_16x16x32_bf16 v[184:187], v[212:215], v[32:35], v[184:187]
    v_mfma_f32_16x16x32_bf16 v[228:231], v[136:139], v[32:35], v[228:231]
    ds_write_b128 v27, v[80:83] offset:0
    v_mfma_f32_16x16x32_bf16 v[244:247], v[152:155], v[32:35], v[244:247]
    ds_write_b128 v27, v[164:167] offset:1024
    v_mfma_f32_16x16x32_bf16 v[88:91], v[148:151], v[36:39], v[88:91]
    ds_write_b128 v27, v[180:183] offset:2048
    v_mfma_f32_16x16x32_bf16 v[172:175], v[196:199], v[36:39], v[172:175]
    ds_write_b128 v27, v[224:227] offset:3072
    v_mfma_f32_16x16x32_bf16 v[188:191], v[212:215], v[36:39], v[188:191]
    ds_write_b128 v27, v[240:243] offset:4096
    v_mfma_f32_16x16x32_bf16 v[232:235], v[136:139], v[36:39], v[232:235]
    ds_write_b128 v27, v[84:87] offset:5120
    v_mfma_f32_16x16x32_bf16 v[248:251], v[152:155], v[36:39], v[248:251]
    ds_write_b128 v27, v[168:171] offset:6144
    v_mfma_f32_16x16x32_bf16 v[160:163], v[148:151], v[40:43], v[160:163]
    ds_write_b128 v27, v[184:187] offset:7168
    v_mfma_f32_16x16x32_bf16 v[176:179], v[196:199], v[40:43], v[176:179]
    ds_write_b128 v27, v[228:231] offset:8192
    v_mfma_f32_16x16x32_bf16 v[220:223], v[212:215], v[40:43], v[220:223]
    ds_write_b128 v27, v[244:247] offset:9216
    v_mfma_f32_16x16x32_bf16 v[236:239], v[136:139], v[40:43], v[236:239]
    ds_write_b128 v27, v[88:91] offset:10240
    v_mfma_f32_16x16x32_bf16 v[252:255], v[152:155], v[40:43], v[252:255]
    ds_write_b128 v27, v[172:175] offset:11264
    ds_write_b128 v27, v[188:191] offset:12288
    ds_write_b128 v27, v[232:235] offset:13312
    ds_write_b128 v27, v[248:251] offset:14336
    ds_read_b64 v[200:201], v1 offset:0
    ds_read_b64 v[202:203], v1 offset:32
    ds_read_b64 v[216:217], v1 offset:64
    ds_read_b64 v[218:219], v1 offset:96
    ds_read_b64 v[140:141], v1 offset:128
    v_add_u32 v53, 65536, v24
    v_add_u32 v54, 5120, v24
    v_add_u32 v55, 141312, v24
    v_mov_b32 v76, v160
    v_mov_b32 v77, v161
    v_mov_b32 v78, v162
    v_mov_b32 v79, v163
    v_mov_b32 v92, v176
    v_mov_b32 v93, v177
    v_mov_b32 v94, v178
    v_mov_b32 v95, v179
    v_mov_b32 v96, v220
    v_mov_b32 v97, v221
    v_mov_b32 v98, v222
    v_mov_b32 v99, v223
    v_mov_b32 v100, v236
    v_mov_b32 v101, v237
    v_mov_b32 v102, v238
    v_mov_b32 v103, v239
    v_mov_b32 v104, v252
    v_mov_b32 v105, v253
    v_mov_b32 v106, v254
    v_mov_b32 v107, v255
L_G2R:
    s_lshl_b32 s72, s3, 2
    v_mov_b32 v4, 163136
    v_add_u32 v4, s72, v4
    v_mov_b32 v5, 1
    s_waitcnt lgkmcnt(0)
    ds_write_b32 v4, v5
    v_lshlrev_b32 v8, 16, v200
    v_and_b32 v9, 0xffff0000, v200
    v_lshlrev_b32 v10, 16, v201
    v_and_b32 v11, 0xffff0000, v201
    v_lshlrev_b32 v12, 16, v202
    v_and_b32 v13, 0xffff0000, v202
    v_lshlrev_b32 v14, 16, v203
    v_and_b32 v15, 0xffff0000, v203
    v_lshlrev_b32 v16, 16, v216
    v_and_b32 v17, 0xffff0000, v216
    v_lshlrev_b32 v18, 16, v217
    v_and_b32 v19, 0xffff0000, v217
    v_lshlrev_b32 v20, 16, v218
    v_and_b32 v21, 0xffff0000, v218
    v_lshlrev_b32 v22, 16, v219
    v_and_b32 v23, 0xffff0000, v219
    v_lshlrev_b32 v28, 16, v140
    v_and_b32 v29, 0xffff0000, v140
    v_lshlrev_b32 v30, 16, v141
    v_and_b32 v31, 0xffff0000, v141
    v_lshrrev_b32 v6, 2, v0
    v_lshlrev_b32 v6, 7, v6
    v_and_b32 v4, 3, v0
    v_lshl_add_u32 v6, v4, 3, v6
    s_lshl_b32 s72, s3, 5
    s_add_u32 s72, s72, 20480
    v_add_u32 v6, s72, v6
    v_sub_u32 v7, v7, v24
    v_add_u32 v4, 0, v0
    v_mul_u32_u24 v5, 6554, v4
    v_lshrrev_b32 v5, 16, v5
    v_mul_u32_u24 v1, 10, v5
    v_sub_u32 v1, v4, v1
    v_mul_u32_u24 v5, 1280, v5
    v_lshl_add_u32 v56, v1, 4, v5
    v_add_u32 v4, 64, v0
    v_mul_u32_u24 v5, 6554, v4
    v_lshrrev_b32 v5, 16, v5
    v_mul_u32_u24 v1, 10, v5
    v_sub_u32 v1, v4, v1
    v_mul_u32_u24 v5, 1280, v5
    v_lshl_add_u32 v57, v1, 4, v5
    v_add_u32 v4, 128, v0
    v_mul_u32_u24 v5, 6554, v4
    v_lshrrev_b32 v5, 16, v5
    v_mul_u32_u24 v1, 10, v5
    v_sub_u32 v1, v4, v1
    v_mul_u32_u24 v5, 1280, v5
    v_lshl_add_u32 v58, v1, 4, v5
    v_mov_b32 v4, 0x10000000
    v_cmp_gt_u32 vcc, 32, v0
    s_nop 1
    v_cndmask_b32 v58, v4, v58, vcc
    v_add_u32 v7, v7, v53
    v_mov_b32 v4, 163136
    s_mov_b32 s73, 200000
LW_27:
    ds_read_b128 v[60:63], v4
    s_waitcnt lgkmcnt(0)
    v_min_u32 v60, v60, v61
    v_min3_u32 v60, v60, v62, v63
    s_nop 0
    v_readfirstlane_b32 s72, v60
    s_nop 1
    s_cmp_ge_u32 s72, 1
    s_cbranch_scc1 LWD_28
    s_sub_u32 s73, s73, 1
    s_cmp_eq_u32 s73, 0
    s_cbranch_scc1 LWD_28
    s_sleep 0
    s_branch LW_27
LWD_28:
    ds_read_b128 v[108:111], v53 offset:0
    ds_read_b128 v[112:115], v53 offset:1024
    ds_read_b128 v[116:119], v53 offset:2048
    ds_read_b128 v[120:123], v53 offset:3072
    ds_read_b128 v[124:127], v53 offset:4096
    ds_read_b128 v[128:131], v54 offset:0
    ds_read_b128 v[144:147], v54 offset:1024
    ds_read_b128 v[192:195], v54 offset:2048
    ds_read_b128 v[208:211], v54 offset:3072
    ds_read_b128 v[132:135], v54 offset:4096
    ds_read_b128 v[148:151], v55 offset:0
    ds_read_b128 v[196:199], v55 offset:1024
    ds_read_b128 v[212:215], v55 offset:2048
    ds_read_b128 v[136:139], v55 offset:3072
    ds_read_b128 v[152:155], v55 offset:4096
    s_waitcnt lgkmcnt(10)
    v_pk_add_f32 v[76:77], v[76:77], v[108:109]
    v_pk_add_f32 v[78:79], v[78:79], v[110:111]
    v_pk_add_f32 v[92:93], v[92:93], v[112:113]
    v_pk_add_f32 v[94:95], v[94:95], v[114:115]
    v_pk_add_f32 v[96:97], v[96:97], v[116:117]
    v_pk_add_f32 v[98:99], v[98:99], v[118:119]
    v_pk_add_f32 v[100:101], v[100:101], v[120:121]
    v_pk_add_f32 v[102:103], v[102:103], v[122:123]
    v_pk_add_f32 v[104:105], v[104:105], v[124:125]
    v_pk_add_f32 v[106:107], v[106:107], v[126:127]
    s_waitcnt lgkmcnt(5)
    v_pk_add_f32 v[76:77], v[76:77], v[128:129]
    v_pk_add_f32 v[78:79], v[78:79], v[130:131]
    v_pk_add_f32 v[92:93], v[92:93], v[144:145]
    v_pk_add_f32 v[94:95], v[94:95], v[146:147]
    v_pk_add_f32 v[96:97], v[96:97], v[192:193]
    v_pk_add_f32 v[98:99], v[98:99], v[194:195]
    v_pk_add_f32 v[100:101], v[100:101], v[208:209]
    v_pk_add_f32 v[102:103], v[102:103], v[210:211]
    v_pk_add_f32 v[104:105], v[104:105], v[132:133]
    v_pk_add_f32 v[106:107], v[106:107], v[134:135]
    s_waitcnt lgkmcnt(0)
    v_pk_add_f32 v[76:77], v[76:77], v[148:149]
    v_pk_add_f32 v[78:79], v[78:79], v[150:151]
    v_pk_add_f32 v[92:93], v[92:93], v[196:197]
    v_pk_add_f32 v[94:95], v[94:95], v[198:199]
    v_pk_add_f32 v[96:97], v[96:97], v[212:213]
    v_pk_add_f32 v[98:99], v[98:99], v[214:215]
    v_pk_add_f32 v[100:101], v[100:101], v[136:137]
    v_pk_add_f32 v[102:103], v[102:103], v[138:139]
    v_pk_add_f32 v[104:105], v[104:105], v[152:153]
    v_pk_add_f32 v[106:107], v[106:107], v[154:155]
    v_mov_b32 v4, 0xbfb8aa3b
    v_pk_mul_f32 v[200:201], v[76:77], v[4:5] op_sel_hi:[1,0]
    v_pk_mul_f32 v[202:203], v[78:79], v[4:5] op_sel_hi:[1,0]
    v_pk_mul_f32 v[216:217], v[92:93], v[4:5] op_sel_hi:[1,0]
    v_pk_mul_f32 v[218:219], v[94:95], v[4:5] op_sel_hi:[1,0]
    v_pk_mul_f32 v[140:141], v[96:97], v[4:5] op_sel_hi:[1,0]
    v_pk_mul_f32 v[142:143], v[98:99], v[4:5] op_sel_hi:[1,0]
    v_pk_mul_f32 v[156:157], v[100:101], v[4:5] op_sel_hi:[1,0]
    v_pk_mul_f32 v[158:159], v[102:103], v[4:5] op_sel_hi:[1,0]
    v_pk_mul_f32 v[204:205], v[104:105], v[4:5] op_sel_hi:[1,0]
    v_pk_mul_f32 v[206:207], v[106:107], v[4:5] op_sel_hi:[1,0]
    v_exp_f32 v200, v200
    v_exp_f32 v201, v201
    v_exp_f32 v202, v202
    v_exp_f32 v203, v203
    v_exp_f32 v216, v216
    v_exp_f32 v217, v217
    v_exp_f32 v218, v218
    v_exp_f32 v219, v219
    v_exp_f32 v140, v140
    v_exp_f32 v141, v141
    v_exp_f32 v142, v142
    v_exp_f32 v143, v143
    v_exp_f32 v156, v156
    v_exp_f32 v157, v157
    v_exp_f32 v158, v158
    v_exp_f32 v159, v159
    v_exp_f32 v204, v204
    v_exp_f32 v205, v205
    v_exp_f32 v206, v206
    v_exp_f32 v207, v207
    v_pk_add_f32 v[200:201], v[200:201], 1.0 op_sel_hi:[1,0]
    v_pk_add_f32 v[202:203], v[202:203], 1.0 op_sel_hi:[1,0]
    v_pk_add_f32 v[216:217], v[216:217], 1.0 op_sel_hi:[1,0]
    v_pk_add_f32 v[218:219], v[218:219], 1.0 op_sel_hi:[1,0]
    v_pk_add_f32 v[140:141], v[140:141], 1.0 op_sel_hi:[1,0]
    v_pk_add_f32 v[142:143], v[142:143], 1.0 op_sel_hi:[1,0]
    v_pk_add_f32 v[156:157], v[156:157], 1.0 op_sel_hi:[1,0]
    v_pk_add_f32 v[158:159], v[158:159], 1.0 op_sel_hi:[1,0]
    v_pk_add_f32 v[204:205], v[204:205], 1.0 op_sel_hi:[1,0]
    v_pk_add_f32 v[206:207], v[206:207], 1.0 op_sel_hi:[1,0]
    v_rcp_f32 v200, v200
    v_rcp_f32 v201, v201
    v_rcp_f32 v202, v202
    v_rcp_f32 v203, v203
    v_rcp_f32 v216, v216
    v_rcp_f32 v217, v217
    v_rcp_f32 v218, v218
    v_rcp_f32 v219, v219
    v_rcp_f32 v140, v140
    v_rcp_f32 v141, v141
    v_rcp_f32 v142, v142
    v_rcp_f32 v143, v143
    v_rcp_f32 v156, v156
    v_rcp_f32 v157, v157
    v_rcp_f32 v158, v158
    v_rcp_f32 v159, v159
    v_rcp_f32 v204, v204
    v_rcp_f32 v205, v205
    v_rcp_f32 v206, v206
    v_rcp_f32 v207, v207
    v_pk_mul_f32 v[76:77], v[76:77], v[200:201]
    v_pk_mul_f32 v[78:79], v[78:79], v[202:203]
    v_pk_mul_f32 v[92:93], v[92:93], v[216:217]
    v_pk_mul_f32 v[94:95], v[94:95], v[218:219]
    v_pk_mul_f32 v[96:97], v[96:97], v[140:141]
    v_pk_mul_f32 v[98:99], v[98:99], v[142:143]
    v_pk_mul_f32 v[100:101], v[100:101], v[156:157]
    v_pk_mul_f32 v[102:103], v[102:103], v[158:159]
    v_pk_mul_f32 v[104:105], v[104:105], v[204:205]
    v_pk_mul_f32 v[106:107], v[106:107], v[206:207]
    v_mov_b32 v4, 163156
    s_mov_b32 s73, 200000
LW_29:
    ds_read_b32 v5, v4
    s_waitcnt lgkmcnt(0)
    v_readfirstlane_b32 s72, v5
    s_nop 1
    s_cmp_ge_u32 s72, 1
    s_cbranch_scc1 LWD_30
    s_sub_u32 s73, s73, 1
    s_cmp_eq_u32 s73, 0
    s_cbranch_scc1 LWD_30
    s_sleep 0
    s_branch LW_29
LWD_30:
    ds_read_b64_tr_b16 v[108:109], v6 offset:0
    ds_read_b64_tr_b16 v[110:111], v6 offset:2048
    ds_read_b64_tr_b16 v[112:113], v6 offset:4096
    ds_read_b64_tr_b16 v[114:115], v6 offset:6144
    ds_read_b64_tr_b16 v[116:117], v6 offset:8192
    s_waitcnt lgkmcnt(4)
    v_lshlrev_b32 v32, 16, v108
    v_and_b32 v33, 0xffff0000, v108
    v_lshlrev_b32 v34, 16, v109
    v_and_b32 v35, 0xffff0000, v109
    v_pk_fma_f32 v[76:77], v[76:77], v[32:33], v[8:9]
    v_pk_fma_f32 v[78:79], v[78:79], v[34:35], v[10:11]
    v_cvt_pk_bf16_f32 v200, v76, v77
    v_cvt_pk_bf16_f32 v201, v78, v79
    ds_write_b64 v7, v[200:201] offset:0
    s_waitcnt lgkmcnt(3)
    v_lshlrev_b32 v36, 16, v110
    v_and_b32 v37, 0xffff0000, v110
    v_lshlrev_b32 v38, 16, v111
    v_and_b32 v39, 0xffff0000, v111
    v_pk_fma_f32 v[92:93], v[92:93], v[36:37], v[12:13]
    v_pk_fma_f32 v[94:95], v[94:95], v[38:39], v[14:15]
    v_cvt_pk_bf16_f32 v202, v92, v93
    v_cvt_pk_bf16_f32 v203, v94, v95
    ds_write_b64 v7, v[202:203] offset:32
    s_waitcnt lgkmcnt(2)
    v_lshlrev_b32 v40, 16, v112
    v_and_b32 v41, 0xffff0000, v112
    v_lshlrev_b32 v42, 16, v113
    v_and_b32 v43, 0xffff0000, v113
    v_pk_fma_f32 v[96:97], v[96:97], v[40:41], v[16:17]
    v_pk_fma_f32 v[98:99], v[98:99], v[42:43], v[18:19]
    v_cvt_pk_bf16_f32 v216, v96, v97
    v_cvt_pk_bf16_f32 v217, v98, v99
    ds_write_b64 v7, v[216:217] offset:64
    s_waitcnt lgkmcnt(1)
    v_lshlrev_b32 v44, 16, v114
    v_and_b32 v45, 0xffff0000, v114
    v_lshlrev_b32 v46, 16, v115
    v_and_b32 v47, 0xffff0000, v115
    v_pk_fma_f32 v[100:101], v[100:101], v[44:45], v[20:21]
    v_pk_fma_f32 v[102:103], v[102:103], v[46:47], v[22:23]
    v_cvt_pk_bf16_f32 v218, v100, v101
    v_cvt_pk_bf16_f32 v219, v102, v103
    ds_write_b64 v7, v[218:219] offset:96
    s_waitcnt lgkmcnt(0)
    v_lshlrev_b32 v48, 16, v116
    v_and_b32 v49, 0xffff0000, v116
    v_lshlrev_b32 v50, 16, v117
    v_and_b32 v51, 0xffff0000, v117
    v_pk_fma_f32 v[104:105], v[104:105], v[48:49], v[28:29]
    v_pk_fma_f32 v[106:107], v[106:107], v[50:51], v[30:31]
    v_cvt_pk_bf16_f32 v140, v104, v105
    v_cvt_pk_bf16_f32 v141, v106, v107
    ds_write_b64 v7, v[140:141] offset:128
    ds_read_b128 v[60:63], v53 offset:0
    ds_read_b128 v[64:67], v53 offset:1024
    ds_read_b128 v[68:71], v53 offset:2048
    s_waitcnt lgkmcnt(2)
    buffer_store_dwordx4 v[60:63], v56, s[64:67], s83 offen
    s_waitcnt lgkmcnt(1)
    buffer_store_dwordx4 v[64:67], v57, s[64:67], s83 offen
    s_waitcnt lgkmcnt(0)
    buffer_store_dwordx4 v[68:71], v58, s[64:67], s83 offen
    s_branch L_END
L_KTASK:
    s_mov_b32 s52, s18
    s_mov_b32 s53, s19
    s_mov_b32 s54, 163840
    s_mov_b32 s55, 0x00020000
    s_mov_b32 s56, s20
    s_mov_b32 s57, s21
    s_mov_b32 s58, 163840
    s_mov_b32 s59, 0x00020000
    s_mov_b32 s60, s22
    s_mov_b32 s61, s23
    s_mov_b32 s62, 163840
    s_mov_b32 s63, 0x00020000
    s_mov_b32 s64, s24
    s_mov_b32 s65, s25
    s_mov_b32 s66, 163840
    s_mov_b32 s67, 0x00020000
    s_cmp_lt_u32 s3, 4
    s_cbranch_scc1 L_KP1
    s_setprio 2
L_KP1:
    s_cmp_lt_u32 s3, 4
    s_cselect_b32 s91, 1, 2
    s_sub_u32 s91, s3, s91
    s_cmp_ge_u32 s91, 3
    s_cselect_b32 s88, 1, 0
    s_cselect_b32 s72, 3, 0
    s_cselect_b32 s89, 0, 2176
    s_sub_u32 s87, s91, s72
    s_add_u32 s86, s70, s87
    s_min_u32 s86, s86, 639
    s_lshl_b32 s72, s86, 8
    s_lshl_b32 s73, s88, 7
    s_add_u32 s72, s72, s73
    v_lshlrev_b32 v10, 1, v0
    buffer_load_ushort v16, v10, s[52:55], s72 offen
    buffer_load_ushort v17, v10, s[56:59], s72 offen
    buffer_load_ushort v18, v10, s[60:63], s72 offen
    buffer_load_ushort v19, v10, s[64:67], s72 offen
    s_lshl_b32 s72, s86, 1
    s_and_b32 s73, s72, 2
    s_and_b32 s72, s72, -4
    s_load_dword s74, s[26:27], s72
    s_mov_b32 s77, s73
    s_cmp_lg_u32 s3, 7
    s_cbranch_scc1 L_KN7
    s_lshl_b32 s72, s68, 11
    s_and_b32 s73, s69, 7
    s_lshl_b32 s73, s73, 2
    s_add_u32 s72, s72, s73
    s_lshr_b32 s73, s69, 3
    s_lshl_b32 s73, s73, 7
    s_add_u32 s72, s72, s73
    s_add_u32 s72, s72, 21233664
    v_lshlrev_b32 v1, 9, v0
    v_add_u32 v1, s72, v1
    v_lshlrev_b32 v2, 7, v0
    s_lshl_b32 s81, s69, 11
    s_lshl_b32 s73, s68, 8
    s_add_u32 s81, s81, s73
    s_add_u32 s81, s81, 21626368
    v_add_u32 v3, s81, v2
    v_cmp_gt_u32 vcc, 4, v0
    s_nop 1
    v_cndmask_b32 v1, v3, v1, vcc
    v_mov_b32 v3, 33554432
    v_cmp_gt_u32 vcc, 6, v0
    s_nop 1
    v_cndmask_b32 v1, v3, v1, vcc
    v_mov_b32 v2, 0
    buffer_store_dword v2, v1, s[44:47], 0 offen sc1
    v_add_u32 v1, s70, v0
    v_lshlrev_b32 v1, 7, v1
    v_add_u32 v1, 21364736, v1
    v_cmp_gt_u32 vcc, 3, v0
    s_nop 1
    v_cndmask_b32 v1, v3, v1, vcc
    buffer_store_dword v2, v1, s[44:47], 0 offen sc1
L_KN7:
    s_mov_b32 s73, s77
    s_mul_i32 s75, s87, 4352
    s_add_u32 s89, s89, s75
    s_add_u32 s89, s89, 147456
    v_lshlrev_b32 v44, 2, v0
    v_add_u32 v44, s89, v44
    v_add_u32 v45, 1088, v44
    s_mov_b32 s6, 0x00ff00ff
    s_mov_b32 s7, 0x00ff00ff
    s_mov_b32 s8, 0xff00ff00
    s_mov_b32 s9, 0xff00ff00
    v_and_b32 v10, 7, v0
    v_lshrrev_b32 v11, 4, v0
    v_mul_u32_u24 v5, 272, v10
    v_lshl_add_u32 v5, v11, 4, v5
    v_add_u32 v5, s89, v5
    s_cmp_ge_u32 s3, 4
    s_cbranch_scc1 L_KNOZ
    v_mov_b32 v128, 0
    v_mov_b32 v129, 0
    v_mov_b32 v130, 0
    v_mov_b32 v131, 0
    v_mov_b32 v132, 0
    v_mov_b32 v133, 0
    v_mov_b32 v134, 0
    v_mov_b32 v135, 0
    v_mov_b32 v136, 0
    v_mov_b32 v137, 0
    v_mov_b32 v138, 0
    v_mov_b32 v139, 0
    v_mov_b32 v140, 0
    v_mov_b32 v141, 0
    v_mov_b32 v142, 0
    v_mov_b32 v143, 0
    v_mov_b32 v144, 0
    v_mov_b32 v145, 0
    v_mov_b32 v146, 0
    v_mov_b32 v147, 0
    v_mov_b32 v148, 0
    v_mov_b32 v149, 0
    v_mov_b32 v150, 0
    v_mov_b32 v151, 0
    v_mov_b32 v152, 0
    v_mov_b32 v153, 0
    v_mov_b32 v154, 0
    v_mov_b32 v155, 0
    v_mov_b32 v156, 0
    v_mov_b32 v157, 0
    v_mov_b32 v158, 0
    v_mov_b32 v159, 0
    v_mov_b32 v160, 0
    v_mov_b32 v161, 0
    v_mov_b32 v162, 0
    v_mov_b32 v163, 0
    v_mov_b32 v164, 0
    v_mov_b32 v165, 0
    v_mov_b32 v166, 0
    v_mov_b32 v167, 0
    v_mov_b32 v168, 0
    v_mov_b32 v169, 0
    v_mov_b32 v170, 0
    v_mov_b32 v171, 0
    v_mov_b32 v172, 0
    v_mov_b32 v173, 0
    v_mov_b32 v174, 0
    v_mov_b32 v175, 0
    v_mov_b32 v176, 0
    v_mov_b32 v177, 0
    v_mov_b32 v178, 0
    v_mov_b32 v179, 0
    v_mov_b32 v180, 0
    v_mov_b32 v181, 0
    v_mov_b32 v182, 0
    v_mov_b32 v183, 0
    v_mov_b32 v184, 0
    v_mov_b32 v185, 0
    v_mov_b32 v186, 0
    v_mov_b32 v187, 0
    v_mov_b32 v188, 0
    v_mov_b32 v189, 0
    v_mov_b32 v190, 0
    v_mov_b32 v191, 0
    v_mov_b32 v192, 0
    v_mov_b32 v193, 0
    v_mov_b32 v194, 0
    v_mov_b32 v195, 0
    v_mov_b32 v196, 0
    v_mov_b32 v197, 0
    v_mov_b32 v198, 0
    v_mov_b32 v199, 0
    v_mov_b32 v200, 0
    v_mov_b32 v201, 0
    v_mov_b32 v202, 0
    v_mov_b32 v203, 0
    v_mov_b32 v204, 0
    v_mov_b32 v205, 0
    v_mov_b32 v206, 0
    v_mov_b32 v207, 0
    v_mov_b32 v208, 0
    v_mov_b32 v209, 0
    v_mov_b32 v210, 0
    v_mov_b32 v211, 0
    v_mov_b32 v212, 0
    v_mov_b32 v213, 0
    v_mov_b32 v214, 0
    v_mov_b32 v215, 0
    v_mov_b32 v216, 0
    v_mov_b32 v217, 0
    v_mov_b32 v218, 0
    v_mov_b32 v219, 0
    v_mov_b32 v220, 0
    v_mov_b32 v221, 0
    v_mov_b32 v222, 0
    v_mov_b32 v223, 0
    v_mov_b32 v224, 0
    v_mov_b32 v225, 0
    v_mov_b32 v226, 0
    v_mov_b32 v227, 0
    v_mov_b32 v228, 0
    v_mov_b32 v229, 0
    v_mov_b32 v230, 0
    v_mov_b32 v231, 0
    v_mov_b32 v232, 0
    v_mov_b32 v233, 0
    v_mov_b32 v234, 0
    v_mov_b32 v235, 0
    v_mov_b32 v236, 0
    v_mov_b32 v237, 0
    v_mov_b32 v238, 0
    v_mov_b32 v239, 0
    v_mov_b32 v240, 0
    v_mov_b32 v241, 0
    v_mov_b32 v242, 0
    v_mov_b32 v243, 0
    v_mov_b32 v244, 0
    v_mov_b32 v245, 0
    v_mov_b32 v246, 0
    v_mov_b32 v247, 0
    v_mov_b32 v248, 0
    v_mov_b32 v249, 0
    v_mov_b32 v250, 0
    v_mov_b32 v251, 0
    v_mov_b32 v252, 0
    v_mov_b32 v253, 0
    v_mov_b32 v254, 0
    v_mov_b32 v255, 0
L_KNOZ:
    s_lshl_b32 s73, s73, 3
    s_waitcnt lgkmcnt(0)
    s_lshr_b32 s74, s74, s73
    s_lshl_b32 s74, s74, 16
    v_mov_b32 v24, 0x3fb8aa3b
    v_mul_f32 v24, s74, v24
    v_exp_f32 v24, v24
    s_nop 0
    v_cvt_pk_bf16_f32 v24, v24, v24
    v_and_b32 v24, 0xffff0000, v24
    s_cmp_lg_u32 s3, 7
    s_cbranch_scc1 L_KW0
    s_waitcnt vmcnt(2)
    s_branch L_KW1
L_KW0:
    s_waitcnt vmcnt(0)
L_KW1:
    v_lshlrev_b32 v16, 16, v16
    v_lshlrev_b32 v17, 16, v17
    v_lshlrev_b32 v18, 16, v18
    v_lshlrev_b32 v19, 16, v19
    v_mul_f32 v16, 0x3fb8aa3b, v16
    v_exp_f32 v16, v16
    v_mul_f32 v17, v17, v24
    v_cvt_pk_bf16_f32 v16, v16, v16
    v_and_b32 v16, 0xffff0000, v16
    v_mul_f32 v16, v16, v24
    v_mul_f32 v16, 0xbfb8aa3b, v16
    v_mul_f32 v17, 0x3e22f983, v17
    v_add_f32 v25, v24, v24
    v_mul_f32 v54, v18, v25
    v_mul_f32 v55, -v19, v25
    v_mul_f32 v26, 0x41000000, v16
    v_mul_f32 v27, 0x41000000, v17
    v_exp_f32 v26, v26
    v_fract_f32 v27, v27
    v_cos_f32 v28, v27
    v_sin_f32 v29, v27
    v_mul_f32 v50, v26, v28
    v_mul_f32 v51, v26, v29
    v_mul_f32 v26, 0x3f800000, v16
    v_mul_f32 v27, 0x3f800000, v17
    v_exp_f32 v26, v26
    v_fract_f32 v27, v27
    v_cos_f32 v28, v27
    v_sin_f32 v29, v27
    v_mul_f32 v60, v26, v28
    v_mul_f32 v61, -v26, v29
    v_mul_f32 v26, 0x43000000, v16
    v_mul_f32 v27, 0x43000000, v17
    v_exp_f32 v26, v26
    v_fract_f32 v27, v27
    v_cos_f32 v28, v27
    v_sin_f32 v29, v27
    v_mul_f32 v52, v26, v28
    v_mul_f32 v53, -v26, v29
    v_mov_b32 v82, 0x00003f80
    v_cvt_pk_bf16_f32 v83, v50, v51
    ds_write2_b32 v44, v82, v83 offset0:0 offset1:68
    v_pk_mul_f32 v[76:77], v[50:51], v[50:51] op_sel:[0,0] op_sel_hi:[0,1]
    v_pk_fma_f32 v[76:77], v[50:51], v[50:51], v[76:77] op_sel:[1,1,0] op_sel_hi:[1,0,1] neg_lo:[1,0,0]
    v_cvt_pk_bf16_f32 v82, v76, v77
    v_pk_mul_f32 v[78:79], v[76:77], v[50:51] op_sel:[0,0] op_sel_hi:[0,1]
    v_pk_fma_f32 v[78:79], v[76:77], v[50:51], v[78:79] op_sel:[1,1,0] op_sel_hi:[1,0,1] neg_lo:[1,0,0]
    v_cvt_pk_bf16_f32 v83, v78, v79
    ds_write2_b32 v44, v82, v83 offset0:136 offset1:204
    v_pk_mul_f32 v[76:77], v[78:79], v[50:51] op_sel:[0,0] op_sel_hi:[0,1]
    v_pk_fma_f32 v[76:77], v[78:79], v[50:51], v[76:77] op_sel:[1,1,0] op_sel_hi:[1,0,1] neg_lo:[1,0,0]
    v_cvt_pk_bf16_f32 v82, v76, v77
    v_pk_mul_f32 v[78:79], v[76:77], v[50:51] op_sel:[0,0] op_sel_hi:[0,1]
    v_pk_fma_f32 v[78:79], v[76:77], v[50:51], v[78:79] op_sel:[1,1,0] op_sel_hi:[1,0,1] neg_lo:[1,0,0]
    v_cvt_pk_bf16_f32 v83, v78, v79
    ds_write2_b32 v45, v82, v83 offset0:0 offset1:68
    v_pk_mul_f32 v[76:77], v[78:79], v[50:51] op_sel:[0,0] op_sel_hi:[0,1]
    v_pk_fma_f32 v[76:77], v[78:79], v[50:51], v[76:77] op_sel:[1,1,0] op_sel_hi:[1,0,1] neg_lo:[1,0,0]
    v_cvt_pk_bf16_f32 v82, v76, v77
    v_pk_mul_f32 v[78:79], v[76:77], v[50:51] op_sel:[0,0] op_sel_hi:[0,1]
    v_pk_fma_f32 v[78:79], v[76:77], v[50:51], v[78:79] op_sel:[1,1,0] op_sel_hi:[1,0,1] neg_lo:[1,0,0]
    v_cvt_pk_bf16_f32 v83, v78, v79
    ds_write2_b32 v45, v82, v83 offset0:136 offset1:204
    s_mov_b64 exec, s[6:7]
    ds_read_b128 v[84:87], v5 offset:0
    ds_read_b128 v[88:91], v5 offset:64
    ds_read_b128 v[92:95], v5 offset:128
    ds_read_b128 v[96:99], v5 offset:192
    s_mov_b64 exec, -1
    v_pk_mul_f32 v[76:77], v[78:79], v[50:51] op_sel:[0,0] op_sel_hi:[0,1]
    v_pk_fma_f32 v[76:77], v[78:79], v[50:51], v[76:77] op_sel:[1,1,0] op_sel_hi:[1,0,1] neg_lo:[1,0,0]
    v_cvt_pk_bf16_f32 v82, v76, v77
    v_pk_mul_f32 v[78:79], v[76:77], v[50:51] op_sel:[0,0] op_sel_hi:[0,1]
    v_pk_fma_f32 v[78:79], v[76:77], v[50:51], v[78:79] op_sel:[1,1,0] op_sel_hi:[1,0,1] neg_lo:[1,0,0]
    v_cvt_pk_bf16_f32 v83, v78, v79
    ds_write2_b32 v44, v82, v83 offset0:0 offset1:68
    v_pk_mul_f32 v[76:77], v[78:79], v[50:51] op_sel:[0,0] op_sel_hi:[0,1]
    v_pk_fma_f32 v[76:77], v[78:79], v[50:51], v[76:77] op_sel:[1,1,0] op_sel_hi:[1,0,1] neg_lo:[1,0,0]
    v_cvt_pk_bf16_f32 v82, v76, v77
    v_pk_mul_f32 v[78:79], v[76:77], v[50:51] op_sel:[0,0] op_sel_hi:[0,1]
    v_pk_fma_f32 v[78:79], v[76:77], v[50:51], v[78:79] op_sel:[1,1,0] op_sel_hi:[1,0,1] neg_lo:[1,0,0]
    v_cvt_pk_bf16_f32 v83, v78, v79
    ds_write2_b32 v44, v82, v83 offset0:136 offset1:204
    v_pk_mul_f32 v[76:77], v[78:79], v[50:51] op_sel:[0,0] op_sel_hi:[0,1]
    v_pk_fma_f32 v[76:77], v[78:79], v[50:51], v[76:77] op_sel:[1,1,0] op_sel_hi:[1,0,1] neg_lo:[1,0,0]
    v_cvt_pk_bf16_f32 v82, v76, v77
    v_pk_mul_f32 v[78:79], v[76:77], v[50:51] op_sel:[0,0] op_sel_hi:[0,1]
    v_pk_fma_f32 v[78:79], v[76:77], v[50:51], v[78:79] op_sel:[1,1,0] op_sel_hi:[1,0,1] neg_lo:[1,0,0]
    v_cvt_pk_bf16_f32 v83, v78, v79
    ds_write2_b32 v45, v82, v83 offset0:0 offset1:68
    v_pk_mul_f32 v[76:77], v[78:79], v[50:51] op_sel:[0,0] op_sel_hi:[0,1]
    v_pk_fma_f32 v[76:77], v[78:79], v[50:51], v[76:77] op_sel:[1,1,0] op_sel_hi:[1,0,1] neg_lo:[1,0,0]
    v_cvt_pk_bf16_f32 v82, v76, v77
    v_pk_mul_f32 v[78:79], v[76:77], v[50:51] op_sel:[0,0] op_sel_hi:[0,1]
    v_pk_fma_f32 v[78:79], v[76:77], v[50:51], v[78:79] op_sel:[1,1,0] op_sel_hi:[1,0,1] neg_lo:[1,0,0]
    v_cvt_pk_bf16_f32 v83, v78, v79
    ds_write2_b32 v45, v82, v83 offset0:136 offset1:204
    s_mov_b64 exec, s[8:9]
    ds_read_b128 v[84:87], v5 offset:0
    ds_read_b128 v[88:91], v5 offset:64
    ds_read_b128 v[92:95], v5 offset:128
    ds_read_b128 v[96:99], v5 offset:192
    s_mov_b64 exec, -1
    v_pk_mul_f32 v[62:63], v[60:61], v[60:61] op_sel:[0,0] op_sel_hi:[0,1]
    v_pk_fma_f32 v[62:63], v[60:61], v[60:61], v[62:63] op_sel:[1,1,0] op_sel_hi:[1,0,1] neg_lo:[1,0,0]
    v_pk_mul_f32 v[64:65], v[62:63], v[60:61] op_sel:[0,0] op_sel_hi:[0,1]
    v_pk_fma_f32 v[64:65], v[62:63], v[60:61], v[64:65] op_sel:[1,1,0] op_sel_hi:[1,0,1] neg_lo:[1,0,0]
    v_pk_mul_f32 v[66:67], v[64:65], v[60:61] op_sel:[0,0] op_sel_hi:[0,1]
    v_pk_fma_f32 v[66:67], v[64:65], v[60:61], v[66:67] op_sel:[1,1,0] op_sel_hi:[1,0,1] neg_lo:[1,0,0]
    v_pk_mul_f32 v[68:69], v[66:67], v[60:61] op_sel:[0,0] op_sel_hi:[0,1]
    v_pk_fma_f32 v[68:69], v[66:67], v[60:61], v[68:69] op_sel:[1,1,0] op_sel_hi:[1,0,1] neg_lo:[1,0,0]
    v_pk_mul_f32 v[70:71], v[68:69], v[60:61] op_sel:[0,0] op_sel_hi:[0,1]
    v_pk_fma_f32 v[70:71], v[68:69], v[60:61], v[70:71] op_sel:[1,1,0] op_sel_hi:[1,0,1] neg_lo:[1,0,0]
    v_pk_mul_f32 v[72:73], v[70:71], v[60:61] op_sel:[0,0] op_sel_hi:[0,1]
    v_pk_fma_f32 v[72:73], v[70:71], v[60:61], v[72:73] op_sel:[1,1,0] op_sel_hi:[1,0,1] neg_lo:[1,0,0]
    v_cvt_pk_bf16_f32 v82, v54, v55
    v_pk_mul_f32 v[80:81], v[54:55], v[60:61] op_sel:[0,0] op_sel_hi:[0,1]
    v_pk_fma_f32 v[80:81], v[54:55], v[60:61], v[80:81] op_sel:[1,1,0] op_sel_hi:[1,0,1] neg_lo:[1,0,0]
    v_cvt_pk_bf16_f32 v83, v80, v81
    ds_write2_b32 v44, v82, v83 offset0:0 offset1:68
    v_pk_mul_f32 v[80:81], v[54:55], v[62:63] op_sel:[0,0] op_sel_hi:[0,1]
    v_pk_fma_f32 v[80:81], v[54:55], v[62:63], v[80:81] op_sel:[1,1,0] op_sel_hi:[1,0,1] neg_lo:[1,0,0]
    v_cvt_pk_bf16_f32 v82, v80, v81
    v_pk_mul_f32 v[80:81], v[54:55], v[64:65] op_sel:[0,0] op_sel_hi:[0,1]
    v_pk_fma_f32 v[80:81], v[54:55], v[64:65], v[80:81] op_sel:[1,1,0] op_sel_hi:[1,0,1] neg_lo:[1,0,0]
    v_cvt_pk_bf16_f32 v83, v80, v81
    ds_write2_b32 v44, v82, v83 offset0:136 offset1:204
    v_pk_mul_f32 v[80:81], v[54:55], v[66:67] op_sel:[0,0] op_sel_hi:[0,1]
    v_pk_fma_f32 v[80:81], v[54:55], v[66:67], v[80:81] op_sel:[1,1,0] op_sel_hi:[1,0,1] neg_lo:[1,0,0]
    v_cvt_pk_bf16_f32 v82, v80, v81
    v_pk_mul_f32 v[80:81], v[54:55], v[68:69] op_sel:[0,0] op_sel_hi:[0,1]
    v_pk_fma_f32 v[80:81], v[54:55], v[68:69], v[80:81] op_sel:[1,1,0] op_sel_hi:[1,0,1] neg_lo:[1,0,0]
    v_cvt_pk_bf16_f32 v83, v80, v81
    ds_write2_b32 v45, v82, v83 offset0:0 offset1:68
    v_pk_mul_f32 v[80:81], v[54:55], v[70:71] op_sel:[0,0] op_sel_hi:[0,1]
    v_pk_fma_f32 v[80:81], v[54:55], v[70:71], v[80:81] op_sel:[1,1,0] op_sel_hi:[1,0,1] neg_lo:[1,0,0]
    v_cvt_pk_bf16_f32 v82, v80, v81
    v_pk_mul_f32 v[80:81], v[54:55], v[72:73] op_sel:[0,0] op_sel_hi:[0,1]
    v_pk_fma_f32 v[80:81], v[54:55], v[72:73], v[80:81] op_sel:[1,1,0] op_sel_hi:[1,0,1] neg_lo:[1,0,0]
    v_cvt_pk_bf16_f32 v83, v80, v81
    ds_write2_b32 v45, v82, v83 offset0:136 offset1:204
    s_mov_b64 exec, s[6:7]
    ds_read_b128 v[100:103], v5 offset:0
    ds_read_b128 v[104:107], v5 offset:64
    ds_read_b128 v[108:111], v5 offset:128
    ds_read_b128 v[112:115], v5 offset:192
    s_mov_b64 exec, -1
    v_pk_mul_f32 v[56:57], v[54:55], v[52:53] op_sel:[0,0] op_sel_hi:[0,1]
    v_pk_fma_f32 v[56:57], v[54:55], v[52:53], v[56:57] op_sel:[1,1,0] op_sel_hi:[1,0,1] neg_lo:[1,0,0]
    v_cvt_pk_bf16_f32 v82, v56, v57
    v_pk_mul_f32 v[80:81], v[56:57], v[60:61] op_sel:[0,0] op_sel_hi:[0,1]
    v_pk_fma_f32 v[80:81], v[56:57], v[60:61], v[80:81] op_sel:[1,1,0] op_sel_hi:[1,0,1] neg_lo:[1,0,0]
    v_cvt_pk_bf16_f32 v83, v80, v81
    ds_write2_b32 v44, v82, v83 offset0:0 offset1:68
    v_pk_mul_f32 v[80:81], v[56:57], v[62:63] op_sel:[0,0] op_sel_hi:[0,1]
    v_pk_fma_f32 v[80:81], v[56:57], v[62:63], v[80:81] op_sel:[1,1,0] op_sel_hi:[1,0,1] neg_lo:[1,0,0]
    v_cvt_pk_bf16_f32 v82, v80, v81
    v_pk_mul_f32 v[80:81], v[56:57], v[64:65] op_sel:[0,0] op_sel_hi:[0,1]
    v_pk_fma_f32 v[80:81], v[56:57], v[64:65], v[80:81] op_sel:[1,1,0] op_sel_hi:[1,0,1] neg_lo:[1,0,0]
    v_cvt_pk_bf16_f32 v83, v80, v81
    ds_write2_b32 v44, v82, v83 offset0:136 offset1:204
    v_pk_mul_f32 v[80:81], v[56:57], v[66:67] op_sel:[0,0] op_sel_hi:[0,1]
    v_pk_fma_f32 v[80:81], v[56:57], v[66:67], v[80:81] op_sel:[1,1,0] op_sel_hi:[1,0,1] neg_lo:[1,0,0]
    v_cvt_pk_bf16_f32 v82, v80, v81
    v_pk_mul_f32 v[80:81], v[56:57], v[68:69] op_sel:[0,0] op_sel_hi:[0,1]
    v_pk_fma_f32 v[80:81], v[56:57], v[68:69], v[80:81] op_sel:[1,1,0] op_sel_hi:[1,0,1] neg_lo:[1,0,0]
    v_cvt_pk_bf16_f32 v83, v80, v81
    ds_write2_b32 v45, v82, v83 offset0:0 offset1:68
    v_pk_mul_f32 v[80:81], v[56:57], v[70:71] op_sel:[0,0] op_sel_hi:[0,1]
    v_pk_fma_f32 v[80:81], v[56:57], v[70:71], v[80:81] op_sel:[1,1,0] op_sel_hi:[1,0,1] neg_lo:[1,0,0]
    v_cvt_pk_bf16_f32 v82, v80, v81
    v_pk_mul_f32 v[80:81], v[56:57], v[72:73] op_sel:[0,0] op_sel_hi:[0,1]
    v_pk_fma_f32 v[80:81], v[56:57], v[72:73], v[80:81] op_sel:[1,1,0] op_sel_hi:[1,0,1] neg_lo:[1,0,0]
    v_cvt_pk_bf16_f32 v83, v80, v81
    ds_write2_b32 v45, v82, v83 offset0:136 offset1:204
    s_mov_b64 exec, s[8:9]
    ds_read_b128 v[100:103], v5 offset:0
    ds_read_b128 v[104:107], v5 offset:64
    ds_read_b128 v[108:111], v5 offset:128
    ds_read_b128 v[112:115], v5 offset:192
    s_mov_b64 exec, -1
    s_cmp_lg_u32 s3, 7
    s_cbranch_scc1 ARR_31
    s_and_b32 s72, s2, 1
    s_lshl_b32 s72, s72, 7
    s_waitcnt vmcnt(0)
    v_mov_b32 v10, 0
    v_mov_b32 v11, 1
    s_mov_b64 exec, 1
    buffer_atomic_add v11, v10, s[48:51], s72 offen sc1
    s_mov_b64 exec, -1
    v_mov_b32 v10, 163168
    v_mov_b32 v11, 1
    ds_write_b32 v10, v11
ARR_31:
    v_pk_mul_f32 v[54:55], v[56:57], v[52:53] op_sel:[0,0] op_sel_hi:[0,1]
    v_pk_fma_f32 v[54:55], v[56:57], v[52:53], v[54:55] op_sel:[1,1,0] op_sel_hi:[1,0,1] neg_lo:[1,0,0]
    s_waitcnt lgkmcnt(0)
    v_mfma_f32_16x16x32_bf16 v[32:35], v[100:103], v[84:87], 0
    v_mfma_f32_16x16x32_bf16 v[32:35], v[104:107], v[88:91], v[32:35]
    v_mfma_f32_16x16x32_bf16 v[32:35], v[108:111], v[92:95], v[32:35]
    v_mfma_f32_16x16x32_bf16 v[32:35], v[112:115], v[96:99], v[32:35]
    v_cvt_pk_bf16_f32 v82, v54, v55
    v_pk_mul_f32 v[80:81], v[54:55], v[62:63] op_sel:[0,0] op_sel_hi:[0,1]
    v_pk_fma_f32 v[80:81], v[54:55], v[62:63], v[80:81] op_sel:[1,1,0] op_sel_hi:[1,0,1] neg_lo:[1,0,0]
    v_cvt_pk_bf16_f32 v83, v80, v81
    ds_write2_b32 v44, v82, v83 offset0:0 offset1:68
    v_pk_mul_f32 v[80:81], v[54:55], v[66:67] op_sel:[0,0] op_sel_hi:[0,1]
    v_pk_fma_f32 v[80:81], v[54:55], v[66:67], v[80:81] op_sel:[1,1,0] op_sel_hi:[1,0,1] neg_lo:[1,0,0]
    v_cvt_pk_bf16_f32 v82, v80, v81
    v_pk_mul_f32 v[80:81], v[54:55], v[70:71] op_sel:[0,0] op_sel_hi:[0,1]
    v_pk_fma_f32 v[80:81], v[54:55], v[70:71], v[80:81] op_sel:[1,1,0] op_sel_hi:[1,0,1] neg_lo:[1,0,0]
    v_cvt_pk_bf16_f32 v83, v80, v81
    ds_write2_b32 v44, v82, v83 offset0:136 offset1:204
    v_pk_mul_f32 v[56:57], v[54:55], v[52:53] op_sel:[0,0] op_sel_hi:[0,1]
    v_pk_fma_f32 v[56:57], v[54:55], v[52:53], v[56:57] op_sel:[1,1,0] op_sel_hi:[1,0,1] neg_lo:[1,0,0]
    v_cvt_pk_bf16_f32 v82, v56, v57
    v_pk_mul_f32 v[80:81], v[56:57], v[62:63] op_sel:[0,0] op_sel_hi:[0,1]
    v_pk_fma_f32 v[80:81], v[56:57], v[62:63], v[80:81] op_sel:[1,1,0] op_sel_hi:[1,0,1] neg_lo:[1,0,0]
    v_cvt_pk_bf16_f32 v83, v80, v81
    ds_write2_b32 v45, v82, v83 offset0:0 offset1:68
    v_pk_mul_f32 v[80:81], v[56:57], v[66:67] op_sel:[0,0] op_sel_hi:[0,1]
    v_pk_fma_f32 v[80:81], v[56:57], v[66:67], v[80:81] op_sel:[1,1,0] op_sel_hi:[1,0,1] neg_lo:[1,0,0]
    v_cvt_pk_bf16_f32 v82, v80, v81
    v_pk_mul_f32 v[80:81], v[56:57], v[70:71] op_sel:[0,0] op_sel_hi:[0,1]
    v_pk_fma_f32 v[80:81], v[56:57], v[70:71], v[80:81] op_sel:[1,1,0] op_sel_hi:[1,0,1] neg_lo:[1,0,0]
    v_cvt_pk_bf16_f32 v83, v80, v81
    ds_write2_b32 v45, v82, v83 offset0:136 offset1:204
    s_mov_b64 exec, s[6:7]
    ds_read_b128 v[100:103], v5 offset:0
    ds_read_b128 v[104:107], v5 offset:64
    ds_read_b128 v[108:111], v5 offset:128
    ds_read_b128 v[112:115], v5 offset:192
    s_mov_b64 exec, -1
    v_pk_mul_f32 v[54:55], v[56:57], v[52:53] op_sel:[0,0] op_sel_hi:[0,1]
    v_pk_fma_f32 v[54:55], v[56:57], v[52:53], v[54:55] op_sel:[1,1,0] op_sel_hi:[1,0,1] neg_lo:[1,0,0]
    v_cvt_pk_bf16_f32 v82, v54, v55
    v_pk_mul_f32 v[80:81], v[54:55], v[66:67] op_sel:[0,0] op_sel_hi:[0,1]
    v_pk_fma_f32 v[80:81], v[54:55], v[66:67], v[80:81] op_sel:[1,1,0] op_sel_hi:[1,0,1] neg_lo:[1,0,0]
    v_cvt_pk_bf16_f32 v83, v80, v81
    ds_write2_b32 v44, v82, v83 offset0:0 offset1:68
    v_pk_mul_f32 v[56:57], v[54:55], v[52:53] op_sel:[0,0] op_sel_hi:[0,1]
    v_pk_fma_f32 v[56:57], v[54:55], v[52:53], v[56:57] op_sel:[1,1,0] op_sel_hi:[1,0,1] neg_lo:[1,0,0]
    v_cvt_pk_bf16_f32 v82, v56, v57
    v_pk_mul_f32 v[80:81], v[56:57], v[66:67] op_sel:[0,0] op_sel_hi:[0,1]
    v_pk_fma_f32 v[80:81], v[56:57], v[66:67], v[80:81] op_sel:[1,1,0] op_sel_hi:[1,0,1] neg_lo:[1,0,0]
    v_cvt_pk_bf16_f32 v83, v80, v81
    ds_write2_b32 v44, v82, v83 offset0:136 offset1:204
    v_pk_mul_f32 v[54:55], v[56:57], v[52:53] op_sel:[0,0] op_sel_hi:[0,1]
    v_pk_fma_f32 v[54:55], v[56:57], v[52:53], v[54:55] op_sel:[1,1,0] op_sel_hi:[1,0,1] neg_lo:[1,0,0]
    v_cvt_pk_bf16_f32 v82, v54, v55
    v_pk_mul_f32 v[80:81], v[54:55], v[66:67] op_sel:[0,0] op_sel_hi:[0,1]
    v_pk_fma_f32 v[80:81], v[54:55], v[66:67], v[80:81] op_sel:[1,1,0] op_sel_hi:[1,0,1] neg_lo:[1,0,0]
    v_cvt_pk_bf16_f32 v83, v80, v81
    ds_write2_b32 v45, v82, v83 offset0:0 offset1:68
    v_pk_mul_f32 v[56:57], v[54:55], v[52:53] op_sel:[0,0] op_sel_hi:[0,1]
    v_pk_fma_f32 v[56:57], v[54:55], v[52:53], v[56:57] op_sel:[1,1,0] op_sel_hi:[1,0,1] neg_lo:[1,0,0]
    v_cvt_pk_bf16_f32 v82, v56, v57
    v_pk_mul_f32 v[80:81], v[56:57], v[66:67] op_sel:[0,0] op_sel_hi:[0,1]
    v_pk_fma_f32 v[80:81], v[56:57], v[66:67], v[80:81] op_sel:[1,1,0] op_sel_hi:[1,0,1] neg_lo:[1,0,0]
    v_cvt_pk_bf16_f32 v83, v80, v81
    ds_write2_b32 v45, v82, v83 offset0:136 offset1:204
    s_mov_b64 exec, s[8:9]
    ds_read_b128 v[100:103], v5 offset:0
    ds_read_b128 v[104:107], v5 offset:64
    ds_read_b128 v[108:111], v5 offset:128
    ds_read_b128 v[112:115], v5 offset:192
    s_mov_b64 exec, -1
    v_pk_mul_f32 v[54:55], v[56:57], v[52:53] op_sel:[0,0] op_sel_hi:[0,1]
    v_pk_fma_f32 v[54:55], v[56:57], v[52:53], v[54:55] op_sel:[1,1,0] op_sel_hi:[1,0,1] neg_lo:[1,0,0]
    s_waitcnt lgkmcnt(0)
    v_mfma_f32_16x16x32_bf16 v[36:39], v[100:103], v[84:87], 0
    v_mfma_f32_16x16x32_bf16 v[36:39], v[104:107], v[88:91], v[36:39]
    v_mfma_f32_16x16x32_bf16 v[36:39], v[108:111], v[92:95], v[36:39]
    v_mfma_f32_16x16x32_bf16 v[36:39], v[112:115], v[96:99], v[36:39]
    v_cvt_pk_bf16_f32 v82, v54, v55
    v_pk_mul_f32 v[56:57], v[54:55], v[52:53] op_sel:[0,0] op_sel_hi:[0,1]
    v_pk_fma_f32 v[56:57], v[54:55], v[52:53], v[56:57] op_sel:[1,1,0] op_sel_hi:[1,0,1] neg_lo:[1,0,0]
    v_cvt_pk_bf16_f32 v83, v56, v57
    ds_write2_b32 v44, v82, v83 offset0:0 offset1:68
    v_pk_mul_f32 v[54:55], v[56:57], v[52:53] op_sel:[0,0] op_sel_hi:[0,1]
    v_pk_fma_f32 v[54:55], v[56:57], v[52:53], v[54:55] op_sel:[1,1,0] op_sel_hi:[1,0,1] neg_lo:[1,0,0]
    v_cvt_pk_bf16_f32 v82, v54, v55
    v_pk_mul_f32 v[56:57], v[54:55], v[52:53] op_sel:[0,0] op_sel_hi:[0,1]
    v_pk_fma_f32 v[56:57], v[54:55], v[52:53], v[56:57] op_sel:[1,1,0] op_sel_hi:[1,0,1] neg_lo:[1,0,0]
    v_cvt_pk_bf16_f32 v83, v56, v57
    ds_write2_b32 v44, v82, v83 offset0:136 offset1:204
    v_pk_mul_f32 v[54:55], v[56:57], v[52:53] op_sel:[0,0] op_sel_hi:[0,1]
    v_pk_fma_f32 v[54:55], v[56:57], v[52:53], v[54:55] op_sel:[1,1,0] op_sel_hi:[1,0,1] neg_lo:[1,0,0]
    v_cvt_pk_bf16_f32 v82, v54, v55
    v_pk_mul_f32 v[56:57], v[54:55], v[52:53] op_sel:[0,0] op_sel_hi:[0,1]
    v_pk_fma_f32 v[56:57], v[54:55], v[52:53], v[56:57] op_sel:[1,1,0] op_sel_hi:[1,0,1] neg_lo:[1,0,0]
    v_cvt_pk_bf16_f32 v83, v56, v57
    ds_write2_b32 v45, v82, v83 offset0:0 offset1:68
    v_pk_mul_f32 v[54:55], v[56:57], v[52:53] op_sel:[0,0] op_sel_hi:[0,1]
    v_pk_fma_f32 v[54:55], v[56:57], v[52:53], v[54:55] op_sel:[1,1,0] op_sel_hi:[1,0,1] neg_lo:[1,0,0]
    v_cvt_pk_bf16_f32 v82, v54, v55
    v_pk_mul_f32 v[56:57], v[54:55], v[52:53] op_sel:[0,0] op_sel_hi:[0,1]
    v_pk_fma_f32 v[56:57], v[54:55], v[52:53], v[56:57] op_sel:[1,1,0] op_sel_hi:[1,0,1] neg_lo:[1,0,0]
    v_cvt_pk_bf16_f32 v83, v56, v57
    ds_write2_b32 v45, v82, v83 offset0:136 offset1:204
    s_mov_b64 exec, s[6:7]
    ds_read_b128 v[100:103], v5 offset:0
    ds_read_b128 v[104:107], v5 offset:64
    ds_read_b128 v[108:111], v5 offset:128
    ds_read_b128 v[112:115], v5 offset:192
    s_mov_b64 exec, -1
    v_pk_mul_f32 v[54:55], v[56:57], v[52:53] op_sel:[0,0] op_sel_hi:[0,1]
    v_pk_fma_f32 v[54:55], v[56:57], v[52:53], v[54:55] op_sel:[1,1,0] op_sel_hi:[1,0,1] neg_lo:[1,0,0]
    v_cvt_pk_bf16_f32 v82, v54, v55
    ds_write_b32 v44, v82
    s_mov_b64 exec, s[8:9]
    ds_read_b128 v[100:103], v5 offset:0
    ds_read_b128 v[104:107], v5 offset:64
    ds_read_b128 v[108:111], v5 offset:128
    ds_read_b128 v[112:115], v5 offset:192
    s_mov_b64 exec, -1
    v_lshlrev_b32 v10, 4, v0
    s_mul_i32 s72, s87, 768
    s_add_u32 s72, s72, 160512
    v_add_u32 v13, s72, v10
    s_lshl_b32 s77, s87, 2
    s_add_u32 s77, s77, 163280
    s_waitcnt lgkmcnt(0)
    v_mfma_f32_16x16x32_bf16 v[40:43], v[100:103], v[84:87], 0
    v_mfma_f32_16x16x32_bf16 v[40:43], v[104:107], v[88:91], v[40:43]
    v_mfma_f32_16x16x32_bf16 v[40:43], v[108:111], v[92:95], v[40:43]
    v_mfma_f32_16x16x32_bf16 v[40:43], v[112:115], v[96:99], v[40:43]
    s_cmp_ge_u32 s3, 4
    s_cbranch_scc1 L_OWN
    v_add_u32 v10, s89, v10
    v_mov_b32 v11, s77
    v_mov_b32 v12, 1
    ds_write_b128 v10, v[32:35] offset:0
    ds_write_b128 v10, v[36:39] offset:1024
    s_mov_b32 exec_hi, 0xffff
    ds_write_b128 v13, v[40:43]
    s_mov_b64 exec, -1
    ds_write_b32 v11, v12
    s_branch L_G1
L_OWN:
    s_sub_u32 s87, s3, 5
    s_add_u32 s86, s70, s87
    s_cmp_lt_u32 s86, 640
    s_cselect_b32 s90, 0, 33554432
    s_min_u32 s86, s86, 639
    s_mul_i32 s89, s87, 4352
    s_add_u32 s89, s89, 147456
    v_and_b32 v10, 15, v0
    v_lshrrev_b32 v11, 4, v0
    v_lshrrev_b32 v12, 1, v11
    v_and_b32 v15, 1, v11
    v_lshlrev_b32 v6, 8, v12
    v_lshl_add_u32 v6, v15, 3, v6
    v_lshl_add_u32 v6, v10, 4, v6
    v_lshlrev_b32 v7, 7, v11
    v_add_u32 v7, 512, v7
    v_lshlrev_b32 v14, 3, v10
    v_lshrrev_b32 v14, v12, v14
    v_add_u32 v7, v7, v14
    v_mul_u32_u24 v14, 60, v12
    v_add3_u32 v8, v7, v14, 4
    v_lshlrev_b32 v9, 7, v11
    v_lshl_add_u32 v9, v10, 1, v9
    v_add_u32 v9, 1024, v9
    v_add_u32 v6, s89, v6
    v_add_u32 v7, s89, v7
    v_add_u32 v8, s89, v8
    v_add_u32 v9, s89, v9
    v_lshlrev_b32 v4, 4, v0
    v_add_u32 v5, s89, v4
    v_mov_b32 v10, s77
    s_mov_b32 s73, 200000
LW_32:
    ds_read_b32 v12, v10
    s_waitcnt lgkmcnt(0)
    v_readfirstlane_b32 s72, v12
    s_nop 1
    s_cmp_ge_u32 s72, 1
    s_cbranch_scc1 LWD_33
    s_sub_u32 s73, s73, 1
    s_cmp_eq_u32 s73, 0
    s_cbranch_scc1 LWD_33
    s_sleep 1
    s_branch LW_32
LWD_33:
    ds_read_b128 v[44:47], v5 offset:2176
    ds_read_b128 v[48:51], v5 offset:3200
    ds_read_b128 v[52:55], v13
    s_waitcnt lgkmcnt(0)
    v_add_f32 v32, v32, v44
    v_add_f32 v33, v33, v45
    v_add_f32 v34, v34, v46
    v_add_f32 v35, v35, v47
    v_add_f32 v36, v36, v48
    v_add_f32 v37, v37, v49
    v_add_f32 v38, v38, v50
    v_add_f32 v39, v39, v51
    v_add_f32 v40, v40, v52
    v_add_f32 v41, v41, v53
    v_add_f32 v42, v42, v54
    v_add_f32 v43, v43, v55
    v_cvt_pk_bf16_f32 v48, v32, v33
    v_cvt_pk_bf16_f32 v49, v34, v35
    v_cvt_pk_bf16_f32 v50, v36, v37
    v_cvt_pk_bf16_f32 v51, v38, v39
    v_cvt_pk_bf16_f32 v52, v40, v41
    v_cvt_pk_bf16_f32 v53, v42, v43
    v_mov_b32 v10, s77
    v_mov_b32 v11, 2
    ds_write_b32 v10, v11
    ds_write_b64 v6, v[48:49]
    ds_write_b32 v7, v50
    ds_write_b32 v8, v51
    ds_write_b16 v9, v52
    ds_write_b16_d16_hi v9, v52 offset:32
    ds_write_b16 v9, v53 offset:64
    ds_write_b16_d16_hi v9, v53 offset:96
    s_setprio 0
    s_cmp_eq_u32 s3, 7
    s_cbranch_scc1 L_W7P
    s_cmp_eq_u32 s3, 5
    s_cselect_b32 s52, s32, s34
    s_cselect_b32 s53, s33, s35
    s_mov_b32 s54, 2211840
    s_mov_b32 s55, 0x00020000
    s_mul_i32 s72, s68, 276480
    s_lshl_b32 s73, s69, 7
    s_add_u32 s72, s72, s73
    v_lshrrev_b32 v10, 3, v0
    v_and_b32 v11, 7, v0
    v_mul_u32_u24 v12, 3456, v10
    v_lshl_add_u32 v12, v11, 4, v12
    buffer_load_dwordx4 v[128:131], v12, s[52:55], s72 offen
    s_add_u32 s72, s72, 27648
    buffer_load_dwordx4 v[132:135], v12, s[52:55], s72 offen
    s_add_u32 s72, s72, 27648
    buffer_load_dwordx4 v[136:139], v12, s[52:55], s72 offen
    s_add_u32 s72, s72, 27648
    buffer_load_dwordx4 v[140:143], v12, s[52:55], s72 offen
    s_add_u32 s72, s72, 27648
    buffer_load_dwordx4 v[144:147], v12, s[52:55], s72 offen
    s_add_u32 s72, s72, 27648
    buffer_load_dwordx4 v[148:151], v12, s[52:55], s72 offen
    s_add_u32 s72, s72, 27648
    buffer_load_dwordx4 v[152:155], v12, s[52:55], s72 offen
    s_add_u32 s72, s72, 27648
    buffer_load_dwordx4 v[156:159], v12, s[52:55], s72 offen
    s_add_u32 s72, s72, 27648
    buffer_load_dwordx4 v[160:163], v12, s[52:55], s72 offen
    s_add_u32 s72, s72, 27648
    buffer_load_dwordx4 v[164:167], v12, s[52:55], s72 offen
    s_add_u32 s72, s72, 27648
    s_waitcnt vmcnt(9)
    v_lshlrev_b32 v116, 16, v128
    v_and_b32 v117, 0xffff0000, v128
    v_lshlrev_b32 v118, 16, v129
    v_and_b32 v119, 0xffff0000, v129
    v_lshlrev_b32 v120, 16, v130
    v_and_b32 v121, 0xffff0000, v130
    v_lshlrev_b32 v122, 16, v131
    v_and_b32 v123, 0xffff0000, v131
    s_waitcnt vmcnt(8)
    v_lshlrev_b32 v124, 16, v132
    v_and_b32 v125, 0xffff0000, v132
    v_add_f32 v116, v116, v124
    v_add_f32 v117, v117, v125
    v_lshlrev_b32 v126, 16, v133
    v_and_b32 v127, 0xffff0000, v133
    v_add_f32 v118, v118, v126
    v_add_f32 v119, v119, v127
    v_lshlrev_b32 v124, 16, v134
    v_and_b32 v125, 0xffff0000, v134
    v_add_f32 v120, v120, v124
    v_add_f32 v121, v121, v125
    v_lshlrev_b32 v126, 16, v135
    v_and_b32 v127, 0xffff0000, v135
    v_add_f32 v122, v122, v126
    v_add_f32 v123, v123, v127
    s_waitcnt vmcnt(7)
    v_lshlrev_b32 v124, 16, v136
    v_and_b32 v125, 0xffff0000, v136
    v_add_f32 v116, v116, v124
    v_add_f32 v117, v117, v125
    v_lshlrev_b32 v126, 16, v137
    v_and_b32 v127, 0xffff0000, v137
    v_add_f32 v118, v118, v126
    v_add_f32 v119, v119, v127
    v_lshlrev_b32 v124, 16, v138
    v_and_b32 v125, 0xffff0000, v138
    v_add_f32 v120, v120, v124
    v_add_f32 v121, v121, v125
    v_lshlrev_b32 v126, 16, v139
    v_and_b32 v127, 0xffff0000, v139
    v_add_f32 v122, v122, v126
    v_add_f32 v123, v123, v127
    s_waitcnt vmcnt(6)
    v_lshlrev_b32 v124, 16, v140
    v_and_b32 v125, 0xffff0000, v140
    v_add_f32 v116, v116, v124
    v_add_f32 v117, v117, v125
    v_lshlrev_b32 v126, 16, v141
    v_and_b32 v127, 0xffff0000, v141
    v_add_f32 v118, v118, v126
    v_add_f32 v119, v119, v127
    v_lshlrev_b32 v124, 16, v142
    v_and_b32 v125, 0xffff0000, v142
    v_add_f32 v120, v120, v124
    v_add_f32 v121, v121, v125
    v_lshlrev_b32 v126, 16, v143
    v_and_b32 v127, 0xffff0000, v143
    v_add_f32 v122, v122, v126
    v_add_f32 v123, v123, v127
    s_waitcnt vmcnt(5)
    v_lshlrev_b32 v124, 16, v144
    v_and_b32 v125, 0xffff0000, v144
    v_add_f32 v116, v116, v124
    v_add_f32 v117, v117, v125
    v_lshlrev_b32 v126, 16, v145
    v_and_b32 v127, 0xffff0000, v145
    v_add_f32 v118, v118, v126
    v_add_f32 v119, v119, v127
    v_lshlrev_b32 v124, 16, v146
    v_and_b32 v125, 0xffff0000, v146
    v_add_f32 v120, v120, v124
    v_add_f32 v121, v121, v125
    v_lshlrev_b32 v126, 16, v147
    v_and_b32 v127, 0xffff0000, v147
    v_add_f32 v122, v122, v126
    v_add_f32 v123, v123, v127
    s_waitcnt vmcnt(4)
    v_lshlrev_b32 v124, 16, v148
    v_and_b32 v125, 0xffff0000, v148
    v_add_f32 v116, v116, v124
    v_add_f32 v117, v117, v125
    v_lshlrev_b32 v126, 16, v149
    v_and_b32 v127, 0xffff0000, v149
    v_add_f32 v118, v118, v126
    v_add_f32 v119, v119, v127
    v_lshlrev_b32 v124, 16, v150
    v_and_b32 v125, 0xffff0000, v150
    v_add_f32 v120, v120, v124
    v_add_f32 v121, v121, v125
    v_lshlrev_b32 v126, 16, v151
    v_and_b32 v127, 0xffff0000, v151
    v_add_f32 v122, v122, v126
    v_add_f32 v123, v123, v127
    s_waitcnt vmcnt(3)
    v_lshlrev_b32 v124, 16, v152
    v_and_b32 v125, 0xffff0000, v152
    v_add_f32 v116, v116, v124
    v_add_f32 v117, v117, v125
    v_lshlrev_b32 v126, 16, v153
    v_and_b32 v127, 0xffff0000, v153
    v_add_f32 v118, v118, v126
    v_add_f32 v119, v119, v127
    v_lshlrev_b32 v124, 16, v154
    v_and_b32 v125, 0xffff0000, v154
    v_add_f32 v120, v120, v124
    v_add_f32 v121, v121, v125
    v_lshlrev_b32 v126, 16, v155
    v_and_b32 v127, 0xffff0000, v155
    v_add_f32 v122, v122, v126
    v_add_f32 v123, v123, v127
    s_waitcnt vmcnt(2)
    v_lshlrev_b32 v124, 16, v156
    v_and_b32 v125, 0xffff0000, v156
    v_add_f32 v116, v116, v124
    v_add_f32 v117, v117, v125
    v_lshlrev_b32 v126, 16, v157
    v_and_b32 v127, 0xffff0000, v157
    v_add_f32 v118, v118, v126
    v_add_f32 v119, v119, v127
    v_lshlrev_b32 v124, 16, v158
    v_and_b32 v125, 0xffff0000, v158
    v_add_f32 v120, v120, v124
    v_add_f32 v121, v121, v125
    v_lshlrev_b32 v126, 16, v159
    v_and_b32 v127, 0xffff0000, v159
    v_add_f32 v122, v122, v126
    v_add_f32 v123, v123, v127
    s_waitcnt vmcnt(1)
    v_lshlrev_b32 v124, 16, v160
    v_and_b32 v125, 0xffff0000, v160
    v_add_f32 v116, v116, v124
    v_add_f32 v117, v117, v125
    v_lshlrev_b32 v126, 16, v161
    v_and_b32 v127, 0xffff0000, v161
    v_add_f32 v118, v118, v126
    v_add_f32 v119, v119, v127
    v_lshlrev_b32 v124, 16, v162
    v_and_b32 v125, 0xffff0000, v162
    v_add_f32 v120, v120, v124
    v_add_f32 v121, v121, v125
    v_lshlrev_b32 v126, 16, v163
    v_and_b32 v127, 0xffff0000, v163
    v_add_f32 v122, v122, v126
    v_add_f32 v123, v123, v127
    s_waitcnt vmcnt(0)
    v_lshlrev_b32 v124, 16, v164
    v_and_b32 v125, 0xffff0000, v164
    v_add_f32 v116, v116, v124
    v_add_f32 v117, v117, v125
    v_lshlrev_b32 v126, 16, v165
    v_and_b32 v127, 0xffff0000, v165
    v_add_f32 v118, v118, v126
    v_add_f32 v119, v119, v127
    v_lshlrev_b32 v124, 16, v166
    v_and_b32 v125, 0xffff0000, v166
    v_add_f32 v120, v120, v124
    v_add_f32 v121, v121, v125
    v_lshlrev_b32 v126, 16, v167
    v_and_b32 v127, 0xffff0000, v167
    v_add_f32 v122, v122, v126
    v_add_f32 v123, v123, v127
    v_add_f32 v116, v116, v116 row_ror:8
    v_add_f32 v117, v117, v117 row_ror:8
    v_add_f32 v118, v118, v118 row_ror:8
    v_add_f32 v119, v119, v119 row_ror:8
    v_add_f32 v120, v120, v120 row_ror:8
    v_add_f32 v121, v121, v121 row_ror:8
    v_add_f32 v122, v122, v122 row_ror:8
    v_add_f32 v123, v123, v123 row_ror:8
    v_mov_b32 v128, v116
    v_mov_b32 v129, v117
    v_mov_b32 v130, v118
    v_mov_b32 v131, v119
    v_mov_b32 v132, v120
    v_mov_b32 v133, v121
    v_mov_b32 v134, v122
    v_mov_b32 v135, v123
    v_permlane16_swap_b32 v116, v128
    v_permlane16_swap_b32 v117, v129
    v_permlane16_swap_b32 v118, v130
    v_permlane16_swap_b32 v119, v131
    v_permlane16_swap_b32 v120, v132
    v_permlane16_swap_b32 v121, v133
    v_permlane16_swap_b32 v122, v134
    v_permlane16_swap_b32 v123, v135
    v_add_f32 v116, v116, v128
    v_add_f32 v117, v117, v129
    v_add_f32 v118, v118, v130
    v_add_f32 v119, v119, v131
    v_add_f32 v120, v120, v132
    v_add_f32 v121, v121, v133
    v_add_f32 v122, v122, v134
    v_add_f32 v123, v123, v135
    v_mov_b32 v128, v116
    v_mov_b32 v129, v117
    v_mov_b32 v130, v118
    v_mov_b32 v131, v119
    v_mov_b32 v132, v120
    v_mov_b32 v133, v121
    v_mov_b32 v134, v122
    v_mov_b32 v135, v123
    v_permlane32_swap_b32 v116, v128
    v_permlane32_swap_b32 v117, v129
    v_permlane32_swap_b32 v118, v130
    v_permlane32_swap_b32 v119, v131
    v_permlane32_swap_b32 v120, v132
    v_permlane32_swap_b32 v121, v133
    v_permlane32_swap_b32 v122, v134
    v_permlane32_swap_b32 v123, v135
    v_add_f32 v116, v116, v128
    v_add_f32 v117, v117, v129
    v_add_f32 v118, v118, v130
    v_add_f32 v119, v119, v131
    v_add_f32 v120, v120, v132
    v_add_f32 v121, v121, v133
    v_add_f32 v122, v122, v134
    v_add_f32 v123, v123, v135
    v_lshlrev_b32 v10, 5, v0
    v_mov_b32 v11, 33554432
    v_cmp_gt_u32 vcc, 8, v0
    s_nop 1
    v_cndmask_b32 v10, v11, v10, vcc
    s_mul_i32 s72, s68, 13824
    s_mul_i32 s73, s87, 6912
    s_add_u32 s72, s72, s73
    s_lshl_b32 s73, s69, 8
    s_add_u32 s72, s72, s73
    s_add_u32 s72, s72, 24117248
    buffer_store_dwordx4 v[116:119], v10, s[44:47], s72 offen sc1
    buffer_store_dwordx4 v[120:123], v10, s[44:47], s72 offen offset:16 sc1
    v_mov_b32 v10, 163168
    s_mov_b32 s73, 200000
LW_34:
    ds_read_b32 v11, v10
    s_waitcnt lgkmcnt(0)
    v_readfirstlane_b32 s72, v11
    s_nop 1
    s_cmp_ge_u32 s72, 1
    s_cbranch_scc1 LWD_35
    s_sub_u32 s73, s73, 1
    s_cmp_eq_u32 s73, 0
    s_cbranch_scc1 LWD_35
    s_sleep 1
    s_branch LW_34
LWD_35:
    s_lshl_b32 s72, s69, 4
    s_lshl_b32 s73, s68, 1
    s_add_u32 s72, s72, s73
    s_add_u32 s72, s72, s87
    s_lshl_b32 s72, s72, 7
    s_add_u32 s72, s72, 21626880
    s_waitcnt vmcnt(0)
    v_mov_b32 v10, 0
    v_mov_b32 v11, 1
    s_mov_b64 exec, 1
    buffer_store_dword v11, v10, s[44:47], s72 offen sc1
    s_mov_b64 exec, -1
    s_branch L_CONV
L_W7P:
    v_mov_b32 v10, 163104
    s_mov_b32 s73, 200000
LW_36:
    ds_read_b128 v[12:15], v10
    s_waitcnt lgkmcnt(0)
    v_min_u32 v12, v12, v13
    v_min3_u32 v12, v12, v14, v15
    s_nop 0
    v_readfirstlane_b32 s72, v12
    s_nop 1
    s_cmp_ge_u32 s72, 5
    s_cbranch_scc1 LWD_37
    s_sub_u32 s73, s73, 1
    s_cmp_eq_u32 s73, 0
    s_cbranch_scc1 LWD_37
    s_sleep 16
    s_branch LW_36
LWD_37:
    v_mov_b32 v10, 163280
    s_mov_b32 s73, 200000
LW_38:
    ds_read_b96 v[12:14], v10
    s_waitcnt lgkmcnt(0)
    v_min3_u32 v12, v12, v13, v14
    s_nop 0
    v_readfirstlane_b32 s72, v12
    s_nop 1
    s_cmp_ge_u32 s72, 2
    s_cbranch_scc1 LWD_39
    s_sub_u32 s73, s73, 1
    s_cmp_eq_u32 s73, 0
    s_cbranch_scc1 LWD_39
    s_sleep 4
    s_branch LW_38
LWD_39:
    v_lshlrev_b32 v10, 2, v0
    s_mov_b32 s73, 200000
DW_40:
    buffer_load_dword v11, v10, s[48:51], 0 offen sc1
    s_waitcnt vmcnt(0)
    v_readlane_b32 s72, v11, 0
    s_nop 1
    s_cmp_lt_u32 s72, 128
    s_cbranch_scc1 DWN_42
    v_readlane_b32 s72, v11, 32
    s_nop 1
    s_cmp_lt_u32 s72, 128
    s_cbranch_scc1 DWN_42
    s_branch DWD_41
DWN_42:
    s_sub_u32 s73, s73, 1
    s_cmp_eq_u32 s73, 0
    s_cbranch_scc1 DWD_41
    s_sleep 32
    s_branch DW_40
DWD_41:
    v_mov_b32 v12, 163268
    v_mov_b32 v13, 1
    ds_write_b32 v12, v13
    v_lshlrev_b32 v12, 7, v0
    s_lshl_b32 s79, s69, 11
    s_add_u32 s79, s79, 21626880
    s_mov_b32 s80, 21512192
    s_mov_b32 s73, 200000
GW_43:
    buffer_load_dword v13, v12, s[44:47], s80 offen sc1
    buffer_load_dword v14, v12, s[44:47], s79 offen sc1
    s_waitcnt vmcnt(0)
    v_cmp_eq_u32 s[74:75], 1, v13
    s_nop 1
    s_or_b32 s74, s74, 0x0
    s_or_b32 s75, s75, 0xffffff00
    s_and_b32 s72, s74, s75
    v_cmp_eq_u32 s[74:75], 1, v14
    s_nop 1
    s_or_b32 s74, s74, 0xffff0000
    s_or_b32 s75, s75, 0xffffffff
    s_and_b32 s72, s72, s74
    s_and_b32 s72, s72, s75
    s_cmp_eq_u32 s72, -1
    s_cbranch_scc1 GWD_44
    s_sub_u32 s73, s73, 1
    s_cmp_eq_u32 s73, 0
    s_cbranch_scc1 GWD_44
    s_sleep 16
    s_branch GW_43
GWD_44:
    v_lshlrev_b32 v12, 4, v0
    s_lshl_b32 s72, s68, 11
    s_add_u32 s72, s72, 20971520
    s_mov_b32 m0, 161024
    s_lshl_b32 s73, s69, 8
    buffer_load_dwordx4 v12, s[44:47], s72 offen sc1 lds
    buffer_load_dwordx4 v12, s[44:47], s72 offen offset:1024 sc1 lds
    s_add_u32 s73, s73, 24117248
    buffer_load_dword v16, v10, s[44:47], s73 offen sc1
    s_add_u32 s74, s73, 6912
    buffer_load_dword v17, v10, s[44:47], s74 offen sc1
    s_add_u32 s73, s73, 13824
    buffer_load_dword v18, v10, s[44:47], s73 offen sc1
    s_add_u32 s74, s73, 6912
    buffer_load_dword v19, v10, s[44:47], s74 offen sc1
    s_add_u32 s73, s73, 13824
    buffer_load_dword v20, v10, s[44:47], s73 offen sc1
    s_add_u32 s74, s73, 6912
    buffer_load_dword v21, v10, s[44:47], s74 offen sc1
    s_add_u32 s73, s73, 13824
    buffer_load_dword v22, v10, s[44:47], s73 offen sc1
    s_add_u32 s74, s73, 6912
    buffer_load_dword v23, v10, s[44:47], s74 offen sc1
    s_add_u32 s73, s73, 13824
    buffer_load_dword v24, v10, s[44:47], s73 offen sc1
    s_add_u32 s74, s73, 6912
    buffer_load_dword v25, v10, s[44:47], s74 offen sc1
    s_add_u32 s73, s73, 13824
    buffer_load_dword v26, v10, s[44:47], s73 offen sc1
    s_add_u32 s74, s73, 6912
    buffer_load_dword v27, v10, s[44:47], s74 offen sc1
    s_add_u32 s73, s73, 13824
    buffer_load_dword v28, v10, s[44:47], s73 offen sc1
    s_add_u32 s74, s73, 6912
    buffer_load_dword v29, v10, s[44:47], s74 offen sc1
    s_add_u32 s73, s73, 13824
    buffer_load_dword v30, v10, s[44:47], s73 offen sc1
    s_add_u32 s74, s73, 6912
    buffer_load_dword v31, v10, s[44:47], s74 offen sc1
    s_add_u32 s73, s73, 13824
    v_add_u32 v10, 160512, v10
    s_waitcnt vmcnt(0)
    v_add_f32 v16, v16, v18
    v_add_f32 v17, v17, v19
    v_add_f32 v16, v16, v20
    v_add_f32 v17, v17, v21
    v_add_f32 v16, v16, v22
    v_add_f32 v17, v17, v23
    v_add_f32 v16, v16, v24
    v_add_f32 v17, v17, v25
    v_add_f32 v16, v16, v26
    v_add_f32 v17, v17, v27
    v_add_f32 v16, v16, v28
    v_add_f32 v17, v17, v29
    v_add_f32 v16, v16, v30
    v_add_f32 v17, v17, v31
    ds_write_b32 v10, v16
    ds_write_b32 v10, v17 offset:256
    v_mov_b32 v10, 163152
    v_mov_b32 v11, 1
    ds_write_b32 v10, v11
    v_lshlrev_b32 v12, 7, v0
    s_mov_b32 s80, 21495808
    s_mov_b32 s73, 200000
GW_45:
    buffer_load_dword v13, v12, s[44:47], s80 offen sc1
    s_waitcnt vmcnt(0)
    v_cmp_eq_u32 s[74:75], 1, v13
    s_nop 1
    s_or_b32 s74, s74, 0x0
    s_or_b32 s75, s75, 0xffffff00
    s_and_b32 s72, s74, s75
    s_cmp_eq_u32 s72, -1
    s_cbranch_scc1 GWD_46
    s_sub_u32 s73, s73, 1
    s_cmp_eq_u32 s73, 0
    s_cbranch_scc1 GWD_46
    s_sleep 16
    s_branch GW_45
GWD_46:
    v_mov_b32 v10, 163264
    v_mov_b32 v11, 1
    ds_write_b32 v10, v11
L_CONV:
    s_mul_i32 s76, s87, 13312
    s_add_u32 s76, s76, 32768
    s_cmp_eq_u32 s87, 2
    s_cselect_b32 s76, 114688, s76
    s_lshl_b32 s72, s86, 1
    s_and_b32 s79, s72, 2
    s_and_b32 s72, s72, -4
    s_load_dword s78, s[28:29], s72
    v_lshlrev_b32 v4, 1, v0
    v_add_u32 v4, s89, v4
    ds_read_u16 v16, v4 offset:1024
    ds_read_u16 v17, v4 offset:1026
    ds_read_u16 v18, v4 offset:1152
    ds_read_u16 v19, v4 offset:1154
    v_lshlrev_b32 v5, 2, v0
    v_add_u32 v5, s89, v5
    ds_read_b32 v20, v5 offset:768
    ds_read_u16 v21, v5 offset:772
    v_and_b32 v6, 31, v0
    v_lshlrev_b32 v7, 4, v6
    v_add_u32 v7, s89, v7
    ds_read_b128 v[24:27], v7
    v_lshlrev_b32 v7, 3, v6
    v_add_u32 v7, s89, v7
    ds_read_b64 v[28:29], v7 offset:512
    ds_read_u16 v30, v7 offset:520
    s_waitcnt lgkmcnt(0)
    s_lshl_b32 s79, s79, 3
    s_lshr_b32 s78, s78, s79
    s_lshl_b32 s78, s78, 16
    v_and_b32 v8, 1, v0
    v_cmp_eq_u32 vcc, 0, v8
    v_lshl_or_b32 v32, v17, 16, v17
    s_nop 0
    v_cndmask_b32 v9, v17, v16, vcc
    v_lshl_or_b32 v33, v9, 16, v17
    v_lshl_or_b32 v34, v16, 16, v16
    v_mov_b32 v35, v34
    v_lshl_or_b32 v36, v19, 16, v19
    v_cndmask_b32 v9, v19, v18, vcc
    v_lshl_or_b32 v37, v9, 16, v19
    v_lshl_or_b32 v38, v18, 16, v18
    v_mov_b32 v39, v38
    v_lshl_or_b32 v40, v21, 16, v21
    v_and_b32 v9, 0xffff0000, v20
    v_lshrrev_b32 v10, 16, v20
    v_or_b32 v41, v9, v10
    v_alignbit_b32 v42, v20, v20, 16
    v_and_b32 v9, 0xffff, v20
    v_lshl_or_b32 v43, v9, 16, v9
    v_alignbit_b32 v44, v27, v27, 16
    v_alignbit_b32 v45, v26, v26, 16
    v_alignbit_b32 v46, v25, v25, 16
    v_alignbit_b32 v47, v24, v24, 16
    v_and_b32 v9, 0xffff0000, v29
    v_or_b32 v48, v9, v30
    v_and_b32 v9, 0xffff, v29
    v_lshl_or_b32 v49, v9, 16, v9
    v_and_b32 v10, 0xffff0000, v28
    v_or_b32 v50, v10, v9
    v_and_b32 v9, 0xffff, v28
    v_lshl_or_b32 v51, v9, 16, v9
    v_cmp_gt_u32 vcc, 32, v0
    s_nop 1
    v_cndmask_b32 v44, v48, v44, vcc
    v_cndmask_b32 v45, v49, v45, vcc
    v_cndmask_b32 v46, v50, v46, vcc
    v_cndmask_b32 v47, v51, v47, vcc
    v_lshlrev_b32 v4, 4, v0
    v_sub_u32 v5, 9584, v4
    v_add_u32 v5, s76, v5
    v_and_b32 v10, 15, v0
    v_lshrrev_b32 v11, 4, v0
    v_and_b32 v12, 1, v0
    v_add_u32 v13, v10, v12
    v_lshlrev_b32 v13, 1, v13
    v_lshl_add_u32 v13, v11, 4, v13
    v_xor_b32 v12, 1, v12
    v_mul_u32_u24 v12, 4288, v12
    v_add3_u32 v16, v13, v12, s76
    v_add_u32 v17, 1024, v16
    v_add_u32 v18, 2048, v16
    v_add_u32 v19, 3072, v16
    v_lshrrev_b32 v12, 1, v11
    v_sub_u32 v12, v12, v10
    v_lshlrev_b32 v12, 5, v12
    v_and_b32 v13, 1, v11
    v_lshl_add_u32 v12, v13, 4, v12
    s_add_u32 s72, s76, 9056
    v_add_u32 v20, s72, v12
    v_lshlrev_b32 v21, 5, v10
    v_lshl_add_u32 v21, v11, 3, v21
    s_add_u32 s72, s76, 32
    v_add_u32 v21, s72, v21
    v_add_u32 v22, s72, v4
    v_mov_b32 v192, 0
    v_mov_b32 v193, 0
    v_mov_b32 v194, 0
    v_mov_b32 v195, 0
    v_mov_b32 v196, 0
    v_mov_b32 v197, 0
    v_mov_b32 v198, 0
    v_mov_b32 v199, 0
    v_mov_b32 v200, 0
    v_mov_b32 v201, 0
    v_mov_b32 v202, 0
    v_mov_b32 v203, 0
    v_mov_b32 v204, 0
    v_mov_b32 v205, 0
    v_mov_b32 v206, 0
    v_mov_b32 v207, 0
    v_mov_b32 v208, 0
    v_mov_b32 v209, 0
    v_mov_b32 v210, 0
    v_mov_b32 v211, 0
    v_mov_b32 v212, 0
    v_mov_b32 v213, 0
    v_mov_b32 v214, 0
    v_mov_b32 v215, 0
    v_mov_b32 v216, 0
    v_mov_b32 v217, 0
    v_mov_b32 v218, 0
    v_mov_b32 v219, 0
    v_mov_b32 v220, 0
    v_mov_b32 v221, 0
    v_mov_b32 v222, 0
    v_mov_b32 v223, 0
    v_mov_b32 v10, 163264
    s_mov_b32 s73, 200000
LW_47:
    ds_read_b32 v11, v10
    s_waitcnt lgkmcnt(0)
    v_readfirstlane_b32 s72, v11
    s_nop 1
    s_cmp_ge_u32 s72, 1
    s_cbranch_scc1 LWD_48
    s_sub_u32 s73, s73, 1
    s_cmp_eq_u32 s73, 0
    s_cbranch_scc1 LWD_48
    s_sleep 16
    s_branch LW_47
LWD_48:
    v_mov_b32 v10, 163104
    s_mov_b32 s73, 200000
LW_49:
    ds_read_b128 v[12:15], v10
    s_waitcnt lgkmcnt(0)
    v_min_u32 v12, v12, v13
    v_min3_u32 v12, v12, v14, v15
    s_nop 0
    v_readfirstlane_b32 s72, v12
    s_nop 1
    s_cmp_ge_u32 s72, 8
    s_cbranch_scc1 LWD_50
    s_sub_u32 s73, s73, 1
    s_cmp_eq_u32 s73, 0
    s_cbranch_scc1 LWD_50
    s_sleep 8
    s_branch LW_49
LWD_50:
    s_lshl_b32 s72, s86, 12
    s_add_u32 s72, s72, 8388608
    s_add_u32 s73, s72, 2
    s_add_u32 m0, s76, 32
    s_nop 0
    buffer_load_dwordx4 v4, s[44:47], s72 offen offset:0 sc1 lds
    buffer_load_dwordx4 v4, s[44:47], s72 offen offset:1024 sc1 lds
    buffer_load_dwordx4 v4, s[44:47], s72 offen offset:2048 sc1 lds
    buffer_load_dwordx4 v4, s[44:47], s72 offen offset:3072 sc1 lds
    s_add_u32 m0, s76, 4320
    s_nop 0
    buffer_load_dwordx4 v4, s[44:47], s73 offen offset:0 sc1 lds
    buffer_load_dwordx4 v4, s[44:47], s73 offen offset:1024 sc1 lds
    buffer_load_dwordx4 v4, s[44:47], s73 offen offset:2048 sc1 lds
    buffer_load_dwordx4 v4, s[44:47], s73 offen offset:3072 sc1 lds
    ds_write_b128 v5, v[36:39]
    ds_write_b128 v5, v[32:35] offset:1024
    ds_write_b128 v5, v[40:43] offset:2048
    ds_write_b128 v5, v[44:47] offset:3072
    v_mov_b32 v8, 0
    v_mov_b32 v9, 0
    v_lshlrev_b32 v6, 3, v0
    v_add_u32 v6, s76, v6
    ds_write_b64 v6, v[8:9] offset:12672
    v_and_b32 v6, 7, v0
    v_lshlrev_b32 v6, 2, v6
    v_add_u32 v6, s76, v6
    ds_write_b32 v6, v8 offset:0
    ds_write_b32 v6, v8 offset:4288
    s_waitcnt vmcnt(0)
    v_mov_b32 v6, s76
    ds_read_b32 v8, v6 offset:32
    s_waitcnt lgkmcnt(0)
    v_lshlrev_b32 v8, 16, v8
    ds_write_b32 v6, v8 offset:4316
    ds_read2_b32 v[64:65], v16 offset0:0 offset1:1
    ds_read2_b32 v[66:67], v16 offset0:2 offset1:3
    ds_read_b128 v[96:99], v20 offset:3584
    ds_read2_b32 v[68:69], v16 offset0:128 offset1:129
    ds_read2_b32 v[70:71], v16 offset0:130 offset1:131
    ds_read_b128 v[100:103], v20 offset:3072
    ds_read2_b32 v[72:73], v17 offset0:0 offset1:1
    ds_read2_b32 v[74:75], v17 offset0:2 offset1:3
    ds_read_b128 v[104:107], v20 offset:2560
    ds_read2_b32 v[76:77], v17 offset0:128 offset1:129
    ds_read2_b32 v[78:79], v17 offset0:130 offset1:131
    ds_read_b128 v[108:111], v20 offset:2048
    ds_read2_b32 v[80:81], v18 offset0:0 offset1:1
    ds_read2_b32 v[82:83], v18 offset0:2 offset1:3
    ds_read_b128 v[112:115], v20 offset:1536
    ds_read2_b32 v[84:85], v18 offset0:128 offset1:129
    ds_read2_b32 v[86:87], v18 offset0:130 offset1:131
    ds_read_b128 v[116:119], v20 offset:1024
    ds_read2_b32 v[88:89], v19 offset0:0 offset1:1
    ds_read2_b32 v[90:91], v19 offset0:2 offset1:3
    ds_read_b128 v[120:123], v20 offset:512
    ds_read2_b32 v[92:93], v19 offset0:128 offset1:129
    ds_read2_b32 v[94:95], v19 offset0:130 offset1:131
    ds_read_b128 v[124:127], v20 offset:0
    v_add_u32 v16, 64, v16
    v_add_u32 v17, 64, v17
    v_add_u32 v18, 64, v18
    v_add_u32 v19, 64, v19
    v_add_u32 v20, 64, v20
    s_sub_u32 s79, s3, 4
    s_lshl_b32 s79, s79, 2
    s_add_u32 s79, s79, 163216
    v_mov_b32 v10, s79
    s_mov_b32 s73, 200000
LW_51:
    ds_read_b32 v11, v10
    s_waitcnt lgkmcnt(0)
    v_readfirstlane_b32 s72, v11
    s_nop 1
    s_cmp_ge_u32 s72, 1
    s_cbranch_scc1 LWD_52
    s_sub_u32 s73, s73, 1
    s_cmp_eq_u32 s73, 0
    s_cbranch_scc1 LWD_52
    s_sleep 2
    s_branch LW_51
LWD_52:
    s_setprio 2
    s_mov_b32 s79, 0
L_CVLOOP:
    s_waitcnt lgkmcnt(0)
    v_mfma_f32_16x16x32_bf16 v[192:195], v[64:67], v[96:99], v[192:195]
    ds_read2_b32 v[128:129], v16 offset0:0 offset1:1
    v_mfma_f32_16x16x32_bf16 v[196:199], v[64:67], v[100:103], v[196:199]
    ds_read2_b32 v[130:131], v16 offset0:2 offset1:3
    v_mfma_f32_16x16x32_bf16 v[196:199], v[68:71], v[96:99], v[196:199]
    ds_read_b128 v[160:163], v20 offset:3584
    v_mfma_f32_16x16x32_bf16 v[200:203], v[68:71], v[100:103], v[200:203]
    ds_read2_b32 v[132:133], v16 offset0:128 offset1:129
    v_mfma_f32_16x16x32_bf16 v[200:203], v[64:67], v[104:107], v[200:203]
    ds_read2_b32 v[134:135], v16 offset0:130 offset1:131
    v_mfma_f32_16x16x32_bf16 v[204:207], v[68:71], v[104:107], v[204:207]
    ds_read_b128 v[164:167], v20 offset:3072
    v_mfma_f32_16x16x32_bf16 v[200:203], v[72:75], v[96:99], v[200:203]
    ds_read2_b32 v[136:137], v17 offset0:0 offset1:1
    v_mfma_f32_16x16x32_bf16 v[204:207], v[72:75], v[100:103], v[204:207]
    ds_read2_b32 v[138:139], v17 offset0:2 offset1:3
    v_mfma_f32_16x16x32_bf16 v[208:211], v[72:75], v[104:107], v[208:211]
    ds_read_b128 v[168:171], v20 offset:2560
    v_mfma_f32_16x16x32_bf16 v[204:207], v[64:67], v[108:111], v[204:207]
    ds_read2_b32 v[140:141], v17 offset0:128 offset1:129
    v_mfma_f32_16x16x32_bf16 v[208:211], v[68:71], v[108:111], v[208:211]
    ds_read2_b32 v[142:143], v17 offset0:130 offset1:131
    v_mfma_f32_16x16x32_bf16 v[212:215], v[72:75], v[108:111], v[212:215]
    ds_read_b128 v[172:175], v20 offset:2048
    v_mfma_f32_16x16x32_bf16 v[204:207], v[76:79], v[96:99], v[204:207]
    ds_read2_b32 v[144:145], v18 offset0:0 offset1:1
    v_mfma_f32_16x16x32_bf16 v[208:211], v[76:79], v[100:103], v[208:211]
    ds_read2_b32 v[146:147], v18 offset0:2 offset1:3
    v_mfma_f32_16x16x32_bf16 v[212:215], v[76:79], v[104:107], v[212:215]
    ds_read_b128 v[176:179], v20 offset:1536
    v_mfma_f32_16x16x32_bf16 v[216:219], v[76:79], v[108:111], v[216:219]
    ds_read2_b32 v[148:149], v18 offset0:128 offset1:129
    v_mfma_f32_16x16x32_bf16 v[208:211], v[64:67], v[112:115], v[208:211]
    ds_read2_b32 v[150:151], v18 offset0:130 offset1:131
    v_mfma_f32_16x16x32_bf16 v[212:215], v[68:71], v[112:115], v[212:215]
    ds_read_b128 v[180:183], v20 offset:1024
    v_mfma_f32_16x16x32_bf16 v[216:219], v[72:75], v[112:115], v[216:219]
    ds_read2_b32 v[152:153], v19 offset0:0 offset1:1
    v_mfma_f32_16x16x32_bf16 v[220:223], v[76:79], v[112:115], v[220:223]
    ds_read2_b32 v[154:155], v19 offset0:2 offset1:3
    v_mfma_f32_16x16x32_bf16 v[208:211], v[80:83], v[96:99], v[208:211]
    ds_read_b128 v[184:187], v20 offset:512
    v_mfma_f32_16x16x32_bf16 v[212:215], v[80:83], v[100:103], v[212:215]
    ds_read2_b32 v[156:157], v19 offset0:128 offset1:129
    v_mfma_f32_16x16x32_bf16 v[216:219], v[80:83], v[104:107], v[216:219]
    ds_read2_b32 v[158:159], v19 offset0:130 offset1:131
    v_mfma_f32_16x16x32_bf16 v[220:223], v[80:83], v[108:111], v[220:223]
    ds_read_b128 v[188:191], v20 offset:0
    v_mfma_f32_16x16x32_bf16 v[212:215], v[64:67], v[116:119], v[212:215]
    v_add_u32 v16, 64, v16
    v_mfma_f32_16x16x32_bf16 v[216:219], v[68:71], v[116:119], v[216:219]
    v_add_u32 v17, 64, v17
    v_mfma_f32_16x16x32_bf16 v[220:223], v[72:75], v[116:119], v[220:223]
    v_add_u32 v18, 64, v18
    v_mfma_f32_16x16x32_bf16 v[212:215], v[84:87], v[96:99], v[212:215]
    v_add_u32 v19, 64, v19
    v_mfma_f32_16x16x32_bf16 v[216:219], v[84:87], v[100:103], v[216:219]
    v_add_u32 v20, 64, v20
    v_mfma_f32_16x16x32_bf16 v[220:223], v[84:87], v[104:107], v[220:223]
    v_mfma_f32_16x16x32_bf16 v[216:219], v[64:67], v[120:123], v[216:219]
    v_mfma_f32_16x16x32_bf16 v[220:223], v[68:71], v[120:123], v[220:223]
    v_mfma_f32_16x16x32_bf16 v[216:219], v[88:91], v[96:99], v[216:219]
    v_mfma_f32_16x16x32_bf16 v[220:223], v[88:91], v[100:103], v[220:223]
    v_mfma_f32_16x16x32_bf16 v[220:223], v[64:67], v[124:127], v[220:223]
    v_mfma_f32_16x16x32_bf16 v[220:223], v[92:95], v[96:99], v[220:223]
    s_waitcnt lgkmcnt(0)
    v_mfma_f32_16x16x32_bf16 v[192:195], v[128:131], v[160:163], v[192:195]
    ds_read2_b32 v[64:65], v16 offset0:0 offset1:1
    v_mfma_f32_16x16x32_bf16 v[196:199], v[128:131], v[164:167], v[196:199]
    ds_read2_b32 v[66:67], v16 offset0:2 offset1:3
    v_mfma_f32_16x16x32_bf16 v[196:199], v[132:135], v[160:163], v[196:199]
    ds_read_b128 v[96:99], v20 offset:3584
    v_mfma_f32_16x16x32_bf16 v[200:203], v[132:135], v[164:167], v[200:203]
    ds_read2_b32 v[68:69], v16 offset0:128 offset1:129
    v_mfma_f32_16x16x32_bf16 v[200:203], v[128:131], v[168:171], v[200:203]
    ds_read2_b32 v[70:71], v16 offset0:130 offset1:131
    v_mfma_f32_16x16x32_bf16 v[204:207], v[132:135], v[168:171], v[204:207]
    ds_read_b128 v[100:103], v20 offset:3072
    v_mfma_f32_16x16x32_bf16 v[200:203], v[136:139], v[160:163], v[200:203]
    ds_read2_b32 v[72:73], v17 offset0:0 offset1:1
    v_mfma_f32_16x16x32_bf16 v[204:207], v[136:139], v[164:167], v[204:207]
    ds_read2_b32 v[74:75], v17 offset0:2 offset1:3
    v_mfma_f32_16x16x32_bf16 v[208:211], v[136:139], v[168:171], v[208:211]
    ds_read_b128 v[104:107], v20 offset:2560
    v_mfma_f32_16x16x32_bf16 v[204:207], v[128:131], v[172:175], v[204:207]
    ds_read2_b32 v[76:77], v17 offset0:128 offset1:129
    v_mfma_f32_16x16x32_bf16 v[208:211], v[132:135], v[172:175], v[208:211]
    ds_read2_b32 v[78:79], v17 offset0:130 offset1:131
    v_mfma_f32_16x16x32_bf16 v[212:215], v[136:139], v[172:175], v[212:215]
    ds_read_b128 v[108:111], v20 offset:2048
    v_mfma_f32_16x16x32_bf16 v[204:207], v[140:143], v[160:163], v[204:207]
    ds_read2_b32 v[80:81], v18 offset0:0 offset1:1
    v_mfma_f32_16x16x32_bf16 v[208:211], v[140:143], v[164:167], v[208:211]
    ds_read2_b32 v[82:83], v18 offset0:2 offset1:3
    v_mfma_f32_16x16x32_bf16 v[212:215], v[140:143], v[168:171], v[212:215]
    ds_read_b128 v[112:115], v20 offset:1536
    v_mfma_f32_16x16x32_bf16 v[216:219], v[140:143], v[172:175], v[216:219]
    ds_read2_b32 v[84:85], v18 offset0:128 offset1:129
    v_mfma_f32_16x16x32_bf16 v[208:211], v[128:131], v[176:179], v[208:211]
    ds_read2_b32 v[86:87], v18 offset0:130 offset1:131
    v_mfma_f32_16x16x32_bf16 v[212:215], v[132:135], v[176:179], v[212:215]
    ds_read_b128 v[116:119], v20 offset:1024
    v_mfma_f32_16x16x32_bf16 v[216:219], v[136:139], v[176:179], v[216:219]
    ds_read2_b32 v[88:89], v19 offset0:0 offset1:1
    v_mfma_f32_16x16x32_bf16 v[220:223], v[140:143], v[176:179], v[220:223]
    ds_read2_b32 v[90:91], v19 offset0:2 offset1:3
    v_mfma_f32_16x16x32_bf16 v[208:211], v[144:147], v[160:163], v[208:211]
    ds_read_b128 v[120:123], v20 offset:512
    v_mfma_f32_16x16x32_bf16 v[212:215], v[144:147], v[164:167], v[212:215]
    ds_read2_b32 v[92:93], v19 offset0:128 offset1:129
    v_mfma_f32_16x16x32_bf16 v[216:219], v[144:147], v[168:171], v[216:219]
    ds_read2_b32 v[94:95], v19 offset0:130 offset1:131
    v_mfma_f32_16x16x32_bf16 v[220:223], v[144:147], v[172:175], v[220:223]
    ds_read_b128 v[124:127], v20 offset:0
    v_mfma_f32_16x16x32_bf16 v[212:215], v[128:131], v[180:183], v[212:215]
    v_add_u32 v16, 64, v16
    v_mfma_f32_16x16x32_bf16 v[216:219], v[132:135], v[180:183], v[216:219]
    v_add_u32 v17, 64, v17
    v_mfma_f32_16x16x32_bf16 v[220:223], v[136:139], v[180:183], v[220:223]
    v_add_u32 v18, 64, v18
    v_mfma_f32_16x16x32_bf16 v[212:215], v[148:151], v[160:163], v[212:215]
    v_add_u32 v19, 64, v19
    v_mfma_f32_16x16x32_bf16 v[216:219], v[148:151], v[164:167], v[216:219]
    v_add_u32 v20, 64, v20
    v_mfma_f32_16x16x32_bf16 v[220:223], v[148:151], v[168:171], v[220:223]
    v_mfma_f32_16x16x32_bf16 v[216:219], v[128:131], v[184:187], v[216:219]
    v_mfma_f32_16x16x32_bf16 v[220:223], v[132:135], v[184:187], v[220:223]
    v_mfma_f32_16x16x32_bf16 v[216:219], v[152:155], v[160:163], v[216:219]
    v_mfma_f32_16x16x32_bf16 v[220:223], v[152:155], v[164:167], v[220:223]
    v_mfma_f32_16x16x32_bf16 v[220:223], v[128:131], v[188:191], v[220:223]
    v_mfma_f32_16x16x32_bf16 v[220:223], v[156:159], v[160:163], v[220:223]
    s_add_u32 s79, s79, 1
    s_cmp_lt_u32 s79, 4
    s_cbranch_scc1 L_CVLOOP
    s_waitcnt lgkmcnt(0)
    ds_read_b64 v[64:65], v21 offset:0
    ds_read_b64 v[66:67], v21 offset:512
    ds_read_b64 v[68:69], v21 offset:1024
    ds_read_b64 v[70:71], v21 offset:1536
    ds_read_b64 v[72:73], v21 offset:2048
    ds_read_b64 v[74:75], v21 offset:2560
    ds_read_b64 v[76:77], v21 offset:3072
    ds_read_b64 v[78:79], v21 offset:3584
    v_mov_b32 v23, s78
    s_waitcnt lgkmcnt(7)
    v_lshlrev_b32 v96, 16, v64
    v_and_b32 v97, 0xffff0000, v64
    v_lshlrev_b32 v98, 16, v65
    v_and_b32 v99, 0xffff0000, v65
    v_fmac_f32 v192, v96, v23
    v_fmac_f32 v193, v97, v23
    v_fmac_f32 v194, v98, v23
    v_fmac_f32 v195, v99, v23
    v_cvt_pk_bf16_f32 v80, v192, v193
    v_cvt_pk_bf16_f32 v81, v194, v195
    s_waitcnt lgkmcnt(6)
    v_lshlrev_b32 v96, 16, v66
    v_and_b32 v97, 0xffff0000, v66
    v_lshlrev_b32 v98, 16, v67
    v_and_b32 v99, 0xffff0000, v67
    v_fmac_f32 v196, v96, v23
    v_fmac_f32 v197, v97, v23
    v_fmac_f32 v198, v98, v23
    v_fmac_f32 v199, v99, v23
    v_cvt_pk_bf16_f32 v82, v196, v197
    v_cvt_pk_bf16_f32 v83, v198, v199
    s_waitcnt lgkmcnt(5)
    v_lshlrev_b32 v96, 16, v68
    v_and_b32 v97, 0xffff0000, v68
    v_lshlrev_b32 v98, 16, v69
    v_and_b32 v99, 0xffff0000, v69
    v_fmac_f32 v200, v96, v23
    v_fmac_f32 v201, v97, v23
    v_fmac_f32 v202, v98, v23
    v_fmac_f32 v203, v99, v23
    v_cvt_pk_bf16_f32 v84, v200, v201
    v_cvt_pk_bf16_f32 v85, v202, v203
    s_waitcnt lgkmcnt(4)
    v_lshlrev_b32 v96, 16, v70
    v_and_b32 v97, 0xffff0000, v70
    v_lshlrev_b32 v98, 16, v71
    v_and_b32 v99, 0xffff0000, v71
    v_fmac_f32 v204, v96, v23
    v_fmac_f32 v205, v97, v23
    v_fmac_f32 v206, v98, v23
    v_fmac_f32 v207, v99, v23
    v_cvt_pk_bf16_f32 v86, v204, v205
    v_cvt_pk_bf16_f32 v87, v206, v207
    s_waitcnt lgkmcnt(3)
    v_lshlrev_b32 v96, 16, v72
    v_and_b32 v97, 0xffff0000, v72
    v_lshlrev_b32 v98, 16, v73
    v_and_b32 v99, 0xffff0000, v73
    v_fmac_f32 v208, v96, v23
    v_fmac_f32 v209, v97, v23
    v_fmac_f32 v210, v98, v23
    v_fmac_f32 v211, v99, v23
    v_cvt_pk_bf16_f32 v88, v208, v209
    v_cvt_pk_bf16_f32 v89, v210, v211
    s_waitcnt lgkmcnt(2)
    v_lshlrev_b32 v96, 16, v74
    v_and_b32 v97, 0xffff0000, v74
    v_lshlrev_b32 v98, 16, v75
    v_and_b32 v99, 0xffff0000, v75
    v_fmac_f32 v212, v96, v23
    v_fmac_f32 v213, v97, v23
    v_fmac_f32 v214, v98, v23
    v_fmac_f32 v215, v99, v23
    v_cvt_pk_bf16_f32 v90, v212, v213
    v_cvt_pk_bf16_f32 v91, v214, v215
    s_waitcnt lgkmcnt(1)
    v_lshlrev_b32 v96, 16, v76
    v_and_b32 v97, 0xffff0000, v76
    v_lshlrev_b32 v98, 16, v77
    v_and_b32 v99, 0xffff0000, v77
    v_fmac_f32 v216, v96, v23
    v_fmac_f32 v217, v97, v23
    v_fmac_f32 v218, v98, v23
    v_fmac_f32 v219, v99, v23
    v_cvt_pk_bf16_f32 v92, v216, v217
    v_cvt_pk_bf16_f32 v93, v218, v219
    s_waitcnt lgkmcnt(0)
    v_lshlrev_b32 v96, 16, v78
    v_and_b32 v97, 0xffff0000, v78
    v_lshlrev_b32 v98, 16, v79
    v_and_b32 v99, 0xffff0000, v79
    v_fmac_f32 v220, v96, v23
    v_fmac_f32 v221, v97, v23
    v_fmac_f32 v222, v98, v23
    v_fmac_f32 v223, v99, v23
    v_cvt_pk_bf16_f32 v94, v220, v221
    v_cvt_pk_bf16_f32 v95, v222, v223
    ds_write_b64 v21, v[80:81] offset:0
    ds_write_b64 v21, v[82:83] offset:512
    ds_write_b64 v21, v[84:85] offset:1024
    ds_write_b64 v21, v[86:87] offset:1536
    ds_write_b64 v21, v[88:89] offset:2048
    ds_write_b64 v21, v[90:91] offset:2560
    ds_write_b64 v21, v[92:93] offset:3072
    ds_write_b64 v21, v[94:95] offset:3584
    ds_read_b128 v[100:103], v22 offset:0
    ds_read_b128 v[104:107], v22 offset:1024
    ds_read_b128 v[108:111], v22 offset:2048
    ds_read_b128 v[112:115], v22 offset:3072
    s_lshl_b32 s72, s86, 12
    s_add_u32 s72, s72, 16777216
    s_add_u32 s72, s72, s90
    s_waitcnt lgkmcnt(3)
    buffer_store_dwordx4 v[100:103], v4, s[44:47], s72 offen offset:0 sc1
    s_waitcnt lgkmcnt(2)
    buffer_store_dwordx4 v[104:107], v4, s[44:47], s72 offen offset:1024 sc1
    s_waitcnt lgkmcnt(1)
    buffer_store_dwordx4 v[108:111], v4, s[44:47], s72 offen offset:2048 sc1
    s_waitcnt lgkmcnt(0)
    buffer_store_dwordx4 v[112:115], v4, s[44:47], s72 offen offset:3072 sc1
    s_lshl_b32 s72, s86, 7
    s_add_u32 s72, s72, 21364736
    s_add_u32 s72, s72, s90
    s_waitcnt vmcnt(0)
    v_mov_b32 v6, 0
    v_mov_b32 v7, 1
    s_mov_b64 exec, 1
    buffer_store_dword v7, v6, s[44:47], s72 offen sc1
    s_mov_b64 exec, -1
    s_branch L_END
L_HOUSE:
    s_and_b32 s72, s2, 7
    s_lshr_b32 s73, s2, 3
    s_lshl_b32 s84, s72, 2
    s_and_b32 s74, s73, 3
    s_add_u32 s84, s84, s74
    s_lshr_b32 s85, s73, 2
    v_mov_b32 v12, 163268
    s_mov_b32 s73, 200000
LW_53:
    ds_read_b32 v13, v12
    s_waitcnt lgkmcnt(0)
    v_readfirstlane_b32 s72, v13
    s_nop 1
    s_cmp_ge_u32 s72, 1
    s_cbranch_scc1 LWD_54
    s_sub_u32 s73, s73, 1
    s_cmp_eq_u32 s73, 0
    s_cbranch_scc1 LWD_54
    s_sleep 4
    s_branch LW_53
LWD_54:
    v_lshlrev_b32 v10, 7, v0
    s_mov_b32 s79, 21504000
    s_mov_b32 s73, 200000
GW_55:
    buffer_load_dword v12, v10, s[44:47], s79 offen sc1
    s_waitcnt vmcnt(0)
    v_cmp_eq_u32 s[74:75], 1, v12
    s_nop 1
    s_or_b32 s74, s74, 0x0
    s_or_b32 s75, s75, 0xffffff00
    s_and_b32 s72, s74, s75
    s_cmp_eq_u32 s72, -1
    s_cbranch_scc1 GWD_56
    s_sub_u32 s73, s73, 1
    s_cmp_eq_u32 s73, 0
    s_cbranch_scc1 GWD_56
    s_sleep 16
    s_branch GW_55
GWD_56:
    v_mov_b32 v12, 163164
    v_mov_b32 v13, 1
    ds_write_b32 v12, v13
    v_lshlrev_b32 v4, 4, v0
    v_add_u32 v5, 1024, v4
    s_mul_i32 s81, s85, 276480
    s_add_u32 s81, s81, 12582912
    s_cmp_ge_u32 s2, 216
    s_cselect_b32 s82, 0, 9
    s_cselect_b32 s83, 0, 10
    v_mov_b32 v12, 163088
    s_mov_b32 s73, 200000
LW_57:
    ds_read_b128 v[16:19], v12
    s_waitcnt lgkmcnt(0)
    v_min_u32 v16, v16, v17
    v_min3_u32 v16, v16, v18, v19
    s_nop 0
    v_readfirstlane_b32 s72, v16
    s_nop 1
    s_cmp_ge_u32 s72, s82
    s_cbranch_scc1 LWD_58
    s_sub_u32 s73, s73, 1
    s_cmp_eq_u32 s73, 0
    s_cbranch_scc1 LWD_58
    s_sleep 2
    s_branch LW_57
LWD_58:
    s_add_u32 s80, s81, 168960
    s_mov_b32 m0, 65536
    s_nop 0
    buffer_load_dwordx4 v4, s[44:47], s80 offen offset:0 sc1 lds
    buffer_load_dwordx4 v4, s[44:47], s80 offen offset:1024 sc1 lds
    buffer_load_dwordx4 v4, s[44:47], s80 offen offset:2048 sc1 lds
    buffer_load_dwordx4 v4, s[44:47], s80 offen offset:3072 sc1 lds
    s_mov_b32 m0, 66560
    s_nop 0
    buffer_load_dwordx4 v5, s[44:47], s80 offen offset:3072 sc1 lds
    s_add_u32 s80, s81, 179200
    s_mov_b32 m0, 70656
    s_nop 0
    buffer_load_dwordx4 v4, s[44:47], s80 offen offset:0 sc1 lds
    buffer_load_dwordx4 v4, s[44:47], s80 offen offset:1024 sc1 lds
    buffer_load_dwordx4 v4, s[44:47], s80 offen offset:2048 sc1 lds
    buffer_load_dwordx4 v4, s[44:47], s80 offen offset:3072 sc1 lds
    s_mov_b32 m0, 71680
    s_nop 0
    buffer_load_dwordx4 v5, s[44:47], s80 offen offset:3072 sc1 lds
    s_add_u32 s80, s81, 189440
    s_mov_b32 m0, 75776
    s_nop 0
    buffer_load_dwordx4 v4, s[44:47], s80 offen offset:0 sc1 lds
    buffer_load_dwordx4 v4, s[44:47], s80 offen offset:1024 sc1 lds
    buffer_load_dwordx4 v4, s[44:47], s80 offen offset:2048 sc1 lds
    buffer_load_dwordx4 v4, s[44:47], s80 offen offset:3072 sc1 lds
    s_mov_b32 m0, 76800
    s_nop 0
    buffer_load_dwordx4 v5, s[44:47], s80 offen offset:3072 sc1 lds
    s_add_u32 s80, s81, 199680
    s_mov_b32 m0, 80896
    s_nop 0
    buffer_load_dwordx4 v4, s[44:47], s80 offen offset:0 sc1 lds
    buffer_load_dwordx4 v4, s[44:47], s80 offen offset:1024 sc1 lds
    buffer_load_dwordx4 v4, s[44:47], s80 offen offset:2048 sc1 lds
    buffer_load_dwordx4 v4, s[44:47], s80 offen offset:3072 sc1 lds
    s_mov_b32 m0, 81920
    s_nop 0
    buffer_load_dwordx4 v5, s[44:47], s80 offen offset:3072 sc1 lds
    s_add_u32 s80, s81, 240640
    s_mov_b32 m0, 86016
    s_nop 0
    buffer_load_dwordx4 v4, s[44:47], s80 offen offset:0 sc1 lds
    buffer_load_dwordx4 v4, s[44:47], s80 offen offset:1024 sc1 lds
    buffer_load_dwordx4 v4, s[44:47], s80 offen offset:2048 sc1 lds
    buffer_load_dwordx4 v4, s[44:47], s80 offen offset:3072 sc1 lds
    s_mov_b32 m0, 87040
    s_nop 0
    buffer_load_dwordx4 v5, s[44:47], s80 offen offset:3072 sc1 lds
    s_add_u32 s80, s81, 250880
    s_mov_b32 m0, 91136
    s_nop 0
    buffer_load_dwordx4 v4, s[44:47], s80 offen offset:0 sc1 lds
    buffer_load_dwordx4 v4, s[44:47], s80 offen offset:1024 sc1 lds
    buffer_load_dwordx4 v4, s[44:47], s80 offen offset:2048 sc1 lds
    buffer_load_dwordx4 v4, s[44:47], s80 offen offset:3072 sc1 lds
    s_mov_b32 m0, 92160
    s_nop 0
    buffer_load_dwordx4 v5, s[44:47], s80 offen offset:3072 sc1 lds
    v_mov_b32 v12, 163104
    s_mov_b32 s73, 200000
LW_59:
    ds_read_b128 v[16:19], v12
    s_waitcnt lgkmcnt(0)
    v_min_u32 v16, v16, v17
    v_min3_u32 v16, v16, v18, v19
    s_nop 0
    v_readfirstlane_b32 s72, v16
    s_nop 1
    s_cmp_ge_u32 s72, s82
    s_cbranch_scc1 LWD_60
    s_sub_u32 s73, s73, 1
    s_cmp_eq_u32 s73, 0
    s_cbranch_scc1 LWD_60
    s_sleep 2
    s_branch LW_59
LWD_60:
    s_add_u32 s80, s81, 35840
    s_mov_b32 m0, 131072
    s_nop 0
    buffer_load_dwordx4 v4, s[44:47], s80 offen offset:0 sc1 lds
    buffer_load_dwordx4 v4, s[44:47], s80 offen offset:1024 sc1 lds
    buffer_load_dwordx4 v4, s[44:47], s80 offen offset:2048 sc1 lds
    buffer_load_dwordx4 v4, s[44:47], s80 offen offset:3072 sc1 lds
    s_mov_b32 m0, 132096
    s_nop 0
    buffer_load_dwordx4 v5, s[44:47], s80 offen offset:3072 sc1 lds
    s_add_u32 s80, s81, 46080
    s_mov_b32 m0, 136192
    s_nop 0
    buffer_load_dwordx4 v4, s[44:47], s80 offen offset:0 sc1 lds
    buffer_load_dwordx4 v4, s[44:47], s80 offen offset:1024 sc1 lds
    buffer_load_dwordx4 v4, s[44:47], s80 offen offset:2048 sc1 lds
    buffer_load_dwordx4 v4, s[44:47], s80 offen offset:3072 sc1 lds
    s_mov_b32 m0, 137216
    s_nop 0
    buffer_load_dwordx4 v5, s[44:47], s80 offen offset:3072 sc1 lds
    s_add_u32 s80, s81, 56320
    s_mov_b32 m0, 141312
    s_nop 0
    buffer_load_dwordx4 v4, s[44:47], s80 offen offset:0 sc1 lds
    buffer_load_dwordx4 v4, s[44:47], s80 offen offset:1024 sc1 lds
    buffer_load_dwordx4 v4, s[44:47], s80 offen offset:2048 sc1 lds
    buffer_load_dwordx4 v4, s[44:47], s80 offen offset:3072 sc1 lds
    s_mov_b32 m0, 142336
    s_nop 0
    buffer_load_dwordx4 v5, s[44:47], s80 offen offset:3072 sc1 lds
    v_mov_b32 v12, 163088
    s_mov_b32 s73, 200000
LW_61:
    ds_read_b128 v[16:19], v12
    s_waitcnt lgkmcnt(0)
    v_min_u32 v16, v16, v17
    v_min3_u32 v16, v16, v18, v19
    s_nop 0
    v_readfirstlane_b32 s72, v16
    s_nop 1
    s_cmp_ge_u32 s72, s83
    s_cbranch_scc1 LWD_62
    s_sub_u32 s73, s73, 1
    s_cmp_eq_u32 s73, 0
    s_cbranch_scc1 LWD_62
    s_sleep 2
    s_branch LW_61
LWD_62:
    s_add_u32 s80, s81, 97280
    s_mov_b32 m0, 0
    s_nop 0
    buffer_load_dwordx4 v4, s[44:47], s80 offen offset:0 sc1 lds
    buffer_load_dwordx4 v4, s[44:47], s80 offen offset:1024 sc1 lds
    buffer_load_dwordx4 v4, s[44:47], s80 offen offset:2048 sc1 lds
    buffer_load_dwordx4 v4, s[44:47], s80 offen offset:3072 sc1 lds
    s_mov_b32 m0, 1024
    s_nop 0
    buffer_load_dwordx4 v5, s[44:47], s80 offen offset:3072 sc1 lds
    s_add_u32 s80, s81, 107520
    s_mov_b32 m0, 5120
    s_nop 0
    buffer_load_dwordx4 v4, s[44:47], s80 offen offset:0 sc1 lds
    buffer_load_dwordx4 v4, s[44:47], s80 offen offset:1024 sc1 lds
    buffer_load_dwordx4 v4, s[44:47], s80 offen offset:2048 sc1 lds
    buffer_load_dwordx4 v4, s[44:47], s80 offen offset:3072 sc1 lds
    s_mov_b32 m0, 6144
    s_nop 0
    buffer_load_dwordx4 v5, s[44:47], s80 offen offset:3072 sc1 lds
    s_add_u32 s80, s81, 117760
    s_mov_b32 m0, 10240
    s_nop 0
    buffer_load_dwordx4 v4, s[44:47], s80 offen offset:0 sc1 lds
    buffer_load_dwordx4 v4, s[44:47], s80 offen offset:1024 sc1 lds
    buffer_load_dwordx4 v4, s[44:47], s80 offen offset:2048 sc1 lds
    buffer_load_dwordx4 v4, s[44:47], s80 offen offset:3072 sc1 lds
    s_mov_b32 m0, 11264
    s_nop 0
    buffer_load_dwordx4 v5, s[44:47], s80 offen offset:3072 sc1 lds
    s_add_u32 s80, s81, 128000
    s_mov_b32 m0, 15360
    s_nop 0
    buffer_load_dwordx4 v4, s[44:47], s80 offen offset:0 sc1 lds
    buffer_load_dwordx4 v4, s[44:47], s80 offen offset:1024 sc1 lds
    buffer_load_dwordx4 v4, s[44:47], s80 offen offset:2048 sc1 lds
    buffer_load_dwordx4 v4, s[44:47], s80 offen offset:3072 sc1 lds
    s_mov_b32 m0, 16384
    s_nop 0
    buffer_load_dwordx4 v5, s[44:47], s80 offen offset:3072 sc1 lds
    v_mov_b32 v12, 163104
    s_mov_b32 s73, 200000
LW_63:
    ds_read_b128 v[16:19], v12
    s_waitcnt lgkmcnt(0)
    v_min_u32 v16, v16, v17
    v_min3_u32 v16, v16, v18, v19
    s_nop 0
    v_readfirstlane_b32 s72, v16
    s_nop 1
    s_cmp_ge_u32 s72, s83
    s_cbranch_scc1 LWD_64
    s_sub_u32 s73, s73, 1
    s_cmp_eq_u32 s73, 0
    s_cbranch_scc1 LWD_64
    s_sleep 2
    s_branch LW_63
LWD_64:
    s_add_u32 s80, s81, 261120
    s_mov_b32 m0, 96256
    s_nop 0
    buffer_load_dwordx4 v4, s[44:47], s80 offen offset:0 sc1 lds
    buffer_load_dwordx4 v4, s[44:47], s80 offen offset:1024 sc1 lds
    buffer_load_dwordx4 v4, s[44:47], s80 offen offset:2048 sc1 lds
    buffer_load_dwordx4 v4, s[44:47], s80 offen offset:3072 sc1 lds
    s_mov_b32 m0, 97280
    s_nop 0
    buffer_load_dwordx4 v5, s[44:47], s80 offen offset:3072 sc1 lds
    s_add_u32 s80, s81, 271360
    s_mov_b32 m0, 101376
    s_nop 0
    buffer_load_dwordx4 v4, s[44:47], s80 offen offset:0 sc1 lds
    buffer_load_dwordx4 v4, s[44:47], s80 offen offset:1024 sc1 lds
    buffer_load_dwordx4 v4, s[44:47], s80 offen offset:2048 sc1 lds
    buffer_load_dwordx4 v4, s[44:47], s80 offen offset:3072 sc1 lds
    s_mov_b32 m0, 102400
    s_nop 0
    buffer_load_dwordx4 v5, s[44:47], s80 offen offset:3072 sc1 lds
    s_mov_b32 s60, s16
    s_mov_b32 s61, s17
    s_mov_b32 s62, 2621440
    s_mov_b32 s63, 0x00020000
    s_mul_i32 s78, s84, 81920
    s_mul_i32 s80, s85, 160
    s_add_u32 s78, s78, s80
    v_add_u32 v20, 0, v0
    v_mul_u32_u24 v21, 6554, v20
    v_lshrrev_b32 v21, 16, v21
    v_mul_u32_u24 v22, 10, v21
    v_sub_u32 v22, v20, v22
    v_mul_u32_u24 v21, 1280, v21
    v_lshl_add_u32 v24, v22, 4, v21
    v_add_u32 v20, 64, v0
    v_mul_u32_u24 v21, 6554, v20
    v_lshrrev_b32 v21, 16, v21
    v_mul_u32_u24 v22, 10, v21
    v_sub_u32 v22, v20, v22
    v_mul_u32_u24 v21, 1280, v21
    v_lshl_add_u32 v25, v22, 4, v21
    v_add_u32 v20, 128, v0
    v_mul_u32_u24 v21, 6554, v20
    v_lshrrev_b32 v21, 16, v21
    v_mul_u32_u24 v22, 10, v21
    v_sub_u32 v22, v20, v22
    v_mul_u32_u24 v21, 1280, v21
    v_lshl_add_u32 v26, v22, 4, v21
    v_add_u32 v20, 192, v0
    v_mul_u32_u24 v21, 6554, v20
    v_lshrrev_b32 v21, 16, v21
    v_mul_u32_u24 v22, 10, v21
    v_sub_u32 v22, v20, v22
    v_mul_u32_u24 v21, 1280, v21
    v_lshl_add_u32 v27, v22, 4, v21
    v_add_u32 v20, 256, v0
    v_mul_u32_u24 v21, 6554, v20
    v_lshrrev_b32 v21, 16, v21
    v_mul_u32_u24 v22, 10, v21
    v_sub_u32 v22, v20, v22
    v_mul_u32_u24 v21, 1280, v21
    v_lshl_add_u32 v28, v22, 4, v21
    s_mov_b32 m0, 59392
    s_nop 0
    buffer_load_dwordx4 v24, s[60:63], s78 offen lds
    s_mov_b32 m0, 60416
    s_nop 0
    buffer_load_dwordx4 v25, s[60:63], s78 offen lds
    s_mov_b32 m0, 61440
    s_nop 0
    buffer_load_dwordx4 v26, s[60:63], s78 offen lds
    s_mov_b32 m0, 62464
    s_nop 0
    buffer_load_dwordx4 v27, s[60:63], s78 offen lds
    s_mov_b32 m0, 63488
    s_nop 0
    buffer_load_dwordx4 v28, s[60:63], s78 offen lds
    s_add_u32 s78, s78, 40960
    s_mov_b32 m0, 106496
    s_nop 0
    buffer_load_dwordx4 v24, s[60:63], s78 offen lds
    s_mov_b32 m0, 107520
    s_nop 0
    buffer_load_dwordx4 v25, s[60:63], s78 offen lds
    s_mov_b32 m0, 108544
    s_nop 0
    buffer_load_dwordx4 v26, s[60:63], s78 offen lds
    s_mov_b32 m0, 109568
    s_nop 0
    buffer_load_dwordx4 v27, s[60:63], s78 offen lds
    s_mov_b32 m0, 110592
    s_nop 0
    buffer_load_dwordx4 v28, s[60:63], s78 offen lds
    s_cmp_ge_u32 s2, 216
    s_cbranch_scc1 L_HPOLL
    v_mov_b32 v12, 163216
    s_mov_b32 s73, 200000
LW_65:
    ds_read_b128 v[16:19], v12
    s_waitcnt lgkmcnt(0)
    v_min_u32 v16, v16, v17
    v_min3_u32 v16, v16, v18, v19
    s_nop 0
    v_readfirstlane_b32 s72, v16
    s_nop 1
    s_cmp_ge_u32 s72, 1
    s_cbranch_scc1 LWD_66
    s_sub_u32 s73, s73, 1
    s_cmp_eq_u32 s73, 0
    s_cbranch_scc1 LWD_66
    s_sleep 2
    s_branch LW_65
LWD_66:
L_HPOLL:
    s_lshl_b32 s79, s84, 9
    s_add_u32 s79, s79, 21233664
    s_add_u32 s4, s42, s79
    s_addc_u32 s5, s43, 0
    s_mov_b32 s73, 200000
    s_mov_b32 s79, 0
L_SP:
    s_load_dwordx8 s[8:15], s[4:5], 0 glc
    s_load_dwordx8 s[16:23], s[4:5], 128 glc
    s_load_dwordx8 s[24:31], s[4:5], 256 glc
    s_load_dwordx4 s[52:55], s[4:5], 384 glc
    s_waitcnt lgkmcnt(0)
    s_and_b64 s[8:9], s[8:9], s[10:11]
    s_and_b64 s[8:9], s[8:9], s[12:13]
    s_and_b64 s[8:9], s[8:9], s[14:15]
    s_and_b64 s[8:9], s[8:9], s[16:17]
    s_and_b64 s[8:9], s[8:9], s[18:19]
    s_and_b64 s[8:9], s[8:9], s[20:21]
    s_and_b64 s[8:9], s[8:9], s[22:23]
    s_and_b64 s[8:9], s[8:9], s[24:25]
    s_and_b64 s[8:9], s[8:9], s[26:27]
    s_and_b64 s[8:9], s[8:9], s[28:29]
    s_and_b64 s[8:9], s[8:9], s[30:31]
    s_and_b64 s[8:9], s[8:9], s[52:53]
    s_and_b32 s8, s8, s9
    s_and_b32 s8, s8, s54
    s_cmp_eq_u32 s8, 3
    s_cbranch_scc1 L_SPD
    s_cmp_le_u32 s8, s79
    s_cbranch_scc1 L_SPN
    s_mov_b32 s79, 1
    v_mov_b32 v12, 163160
    v_mov_b32 v13, 1
    ds_write_b32 v12, v13
    s_waitcnt vmcnt(0)
    v_mov_b32 v12, 163232
    v_mov_b32 v13, 1
    ds_write_b32 v12, v13
L_SPN:
    s_sub_u32 s73, s73, 1
    s_cmp_eq_u32 s73, 0
    s_cbranch_scc1 L_SPD
    s_sleep 2
    s_branch L_SP
L_SPD:
    v_mov_b32 v12, 163160
    v_mov_b32 v13, 2
    ds_write_b32 v12, v13
    s_waitcnt vmcnt(0)
    v_mov_b32 v12, 163232
    v_mov_b32 v13, 1
    ds_write_b32 v12, v13
    s_mul_i32 s79, s85, 10240
    s_add_u32 s79, s79, 21364736
    s_add_u32 s80, s79, 8192
    v_mov_b32 v12, 163248
    s_mov_b32 s73, 200000
LW_67:
    ds_read_b128 v[16:19], v12
    s_waitcnt lgkmcnt(0)
    v_min_u32 v16, v16, v17
    v_min3_u32 v16, v16, v18, v19
    s_nop 0
    v_readfirstlane_b32 s72, v16
    s_nop 1
    s_cmp_ge_u32 s72, 1
    s_cbranch_scc1 LWD_68
    s_sub_u32 s73, s73, 1
    s_cmp_eq_u32 s73, 0
    s_cbranch_scc1 LWD_68
    s_sleep 1
    s_branch LW_67
LWD_68:
    s_mov_b32 s73, 200000
GW_69:
    buffer_load_dword v12, v10, s[44:47], s79 offen sc1
    buffer_load_dword v13, v10, s[44:47], s80 offen sc1
    s_waitcnt vmcnt(0)
    v_cmp_eq_u32 s[74:75], 1, v12
    s_nop 1
    s_or_b32 s74, s74, 0x0
    s_or_b32 s75, s75, 0x0
    s_and_b32 s72, s74, s75
    v_cmp_eq_u32 s[74:75], 1, v13
    s_nop 1
    s_or_b32 s74, s74, 0xffff0000
    s_or_b32 s75, s75, 0xffffffff
    s_and_b32 s72, s72, s74
    s_and_b32 s72, s72, s75
    s_cmp_eq_u32 s72, -1
    s_cbranch_scc1 GWD_70
    s_sub_u32 s73, s73, 1
    s_cmp_eq_u32 s73, 0
    s_cbranch_scc1 GWD_70
    s_sleep 2
    s_branch GW_69
GWD_70:
    v_lshrrev_b32 v4, 3, v0
    v_and_b32 v5, 7, v0
    v_lshlrev_b32 v4, 12, v4
    v_lshl_add_u32 v4, v5, 4, v4
    s_mul_i32 s72, s85, 327680
    s_lshl_b32 s73, s84, 7
    s_add_u32 s72, s72, s73
    s_add_u32 s72, s72, 16777216
    s_mov_b32 m0, 20480
    s_add_u32 s73, s72, 0
    buffer_load_dwordx4 v4, s[44:47], s73 offen sc1 lds
    s_mov_b32 m0, 21504
    s_add_u32 s73, s72, 32768
    buffer_load_dwordx4 v4, s[44:47], s73 offen sc1 lds
    s_mov_b32 m0, 22528
    s_add_u32 s73, s72, 65536
    buffer_load_dwordx4 v4, s[44:47], s73 offen sc1 lds
    s_mov_b32 m0, 23552
    s_add_u32 s73, s72, 98304
    buffer_load_dwordx4 v4, s[44:47], s73 offen sc1 lds
    s_mov_b32 m0, 24576
    s_add_u32 s73, s72, 131072
    buffer_load_dwordx4 v4, s[44:47], s73 offen sc1 lds
    s_mov_b32 m0, 25600
    s_add_u32 s73, s72, 163840
    buffer_load_dwordx4 v4, s[44:47], s73 offen sc1 lds
    s_mov_b32 m0, 26624
    s_add_u32 s73, s72, 196608
    buffer_load_dwordx4 v4, s[44:47], s73 offen sc1 lds
    s_mov_b32 m0, 27648
    s_add_u32 s73, s72, 229376
    buffer_load_dwordx4 v4, s[44:47], s73 offen sc1 lds
    s_mov_b32 m0, 28672
    s_add_u32 s73, s72, 262144
    buffer_load_dwordx4 v4, s[44:47], s73 offen sc1 lds
    s_mov_b32 m0, 29696
    s_add_u32 s73, s72, 294912
    buffer_load_dwordx4 v4, s[44:47], s73 offen sc1 lds
    s_waitcnt vmcnt(0)
    v_mov_b32 v12, 163156
    v_mov_b32 v13, 1
    ds_write_b32 v12, v13
    s_branch L_END
L_PRE:
    s_mov_b32 s52, s16
    s_mov_b32 s53, s17
    s_mov_b32 s54, 2621440
    s_mov_b32 s55, 0x00020000
    s_mov_b32 s56, s36
    s_mov_b32 s57, s37
    s_mov_b32 s58, 2211840
    s_mov_b32 s59, 0x00020000
    s_sub_u32 s76, s2, 216
    s_lshl_b32 s77, s76, 3
    s_add_u32 s77, s77, s3
    s_mul_i32 s72, s77, 52429
    s_lshr_b32 s78, s72, 18
    s_mul_i32 s72, s78, 5
    s_sub_u32 s79, s77, s72
    s_lshl_b32 s80, s3, 13
    s_add_u32 s80, s80, 81920
    s_lshl_b32 s72, s76, 6
    s_lshl_b32 s73, s3, 3
    s_add_u32 s81, s72, s73
    s_mul_i32 s72, s81, 1280
    v_lshrrev_b32 v4, 4, v0
    v_and_b32 v5, 15, v0
    v_mul_u32_u24 v1, 2560, v4
    v_lshl_add_u32 v1, v5, 4, v1
    s_lshl_b32 s82, s76, 7
    s_add_u32 s82, s82, 21495808
    v_lshlrev_b32 v2, 13, v0
    v_mov_b32 v3, 33554432
    v_cmp_gt_u32 vcc, 4, v0
    s_nop 1
    v_cndmask_b32 v2, v3, v2, vcc
    v_mov_b32 v3, 0
    s_cmp_eq_u32 s3, 5
    s_cselect_b32 s73, s82, 33554432
    buffer_store_dword v3, v2, s[44:47], s73 offen sc1
    buffer_load_dwordx4 v[16:19], v1, s[52:55], s72 offen offset:0
    buffer_load_dwordx4 v[36:39], v1, s[52:55], s72 offen offset:1280
    buffer_load_dwordx4 v[20:23], v1, s[52:55], s72 offen offset:256
    buffer_load_dwordx4 v[40:43], v1, s[52:55], s72 offen offset:1536
    buffer_load_dwordx4 v[24:27], v1, s[52:55], s72 offen offset:512
    buffer_load_dwordx4 v[44:47], v1, s[52:55], s72 offen offset:1792
    buffer_load_dwordx4 v[28:31], v1, s[52:55], s72 offen offset:768
    buffer_load_dwordx4 v[48:51], v1, s[52:55], s72 offen offset:2048
    buffer_load_dwordx4 v[32:35], v1, s[52:55], s72 offen offset:1024
    buffer_load_dwordx4 v[52:55], v1, s[52:55], s72 offen offset:2304
    v_lshlrev_b32 v2, 7, v0
    s_cmp_eq_u32 s3, 0
    s_cselect_b32 s60, s42, s38
    s_cselect_b32 s61, s43, s39
    s_cselect_b32 s62, 33554432, 0
    s_cselect_b32 s75, 4096, 64
    s_max_u32 s75, s75, 320
    s_max_u32 s62, s62, 2621440
    s_mov_b32 s63, 0x00020000
    s_cmp_lt_u32 s3, 2
    s_cselect_b32 s74, 0, 33554432
    v_mul_u32_u24 v2, s75, v2
    buffer_load_dword v15, v2, s[60:63], s74 offen
    v_and_b32 v6, 7, v5
    v_xor_b32 v6, s3, v6
    v_lshlrev_b32 v6, 4, v6
    v_lshl_add_u32 v6, v5, 10, v6
    v_lshl_add_u32 v6, v4, 2, v6
    v_add_u32 v7, 0x10000, v6
    v_mov_b32 v8, 0
    v_mov_b32 v9, 0
    s_waitcnt vmcnt(9)
    v_lshlrev_b32 v64, 16, v16
    v_and_b32 v66, 0xffff0000, v16
    v_lshlrev_b32 v65, 16, v36
    v_and_b32 v67, 0xffff0000, v36
    v_pk_add_f32 v[8:9], v[8:9], v[64:65]
    v_pk_add_f32 v[8:9], v[8:9], v[66:67]
    v_lshlrev_b32 v68, 16, v17
    v_and_b32 v70, 0xffff0000, v17
    v_lshlrev_b32 v69, 16, v37
    v_and_b32 v71, 0xffff0000, v37
    v_pk_add_f32 v[8:9], v[8:9], v[68:69]
    v_pk_add_f32 v[8:9], v[8:9], v[70:71]
    v_lshlrev_b32 v72, 16, v18
    v_and_b32 v74, 0xffff0000, v18
    v_lshlrev_b32 v73, 16, v38
    v_and_b32 v75, 0xffff0000, v38
    v_pk_add_f32 v[8:9], v[8:9], v[72:73]
    v_pk_add_f32 v[8:9], v[8:9], v[74:75]
    v_lshlrev_b32 v76, 16, v19
    v_and_b32 v78, 0xffff0000, v19
    v_lshlrev_b32 v77, 16, v39
    v_and_b32 v79, 0xffff0000, v39
    v_pk_add_f32 v[8:9], v[8:9], v[76:77]
    v_pk_add_f32 v[8:9], v[8:9], v[78:79]
    s_waitcnt vmcnt(7)
    v_lshlrev_b32 v80, 16, v20
    v_and_b32 v82, 0xffff0000, v20
    v_lshlrev_b32 v81, 16, v40
    v_and_b32 v83, 0xffff0000, v40
    v_pk_add_f32 v[8:9], v[8:9], v[80:81]
    v_pk_add_f32 v[8:9], v[8:9], v[82:83]
    v_lshlrev_b32 v84, 16, v21
    v_and_b32 v86, 0xffff0000, v21
    v_lshlrev_b32 v85, 16, v41
    v_and_b32 v87, 0xffff0000, v41
    v_pk_add_f32 v[8:9], v[8:9], v[84:85]
    v_pk_add_f32 v[8:9], v[8:9], v[86:87]
    v_lshlrev_b32 v88, 16, v22
    v_and_b32 v90, 0xffff0000, v22
    v_lshlrev_b32 v89, 16, v42
    v_and_b32 v91, 0xffff0000, v42
    v_pk_add_f32 v[8:9], v[8:9], v[88:89]
    v_pk_add_f32 v[8:9], v[8:9], v[90:91]
    v_lshlrev_b32 v92, 16, v23
    v_and_b32 v94, 0xffff0000, v23
    v_lshlrev_b32 v93, 16, v43
    v_and_b32 v95, 0xffff0000, v43
    v_pk_add_f32 v[8:9], v[8:9], v[92:93]
    v_pk_add_f32 v[8:9], v[8:9], v[94:95]
    s_waitcnt vmcnt(5)
    v_lshlrev_b32 v96, 16, v24
    v_and_b32 v98, 0xffff0000, v24
    v_lshlrev_b32 v97, 16, v44
    v_and_b32 v99, 0xffff0000, v44
    v_pk_add_f32 v[8:9], v[8:9], v[96:97]
    v_pk_add_f32 v[8:9], v[8:9], v[98:99]
    v_lshlrev_b32 v100, 16, v25
    v_and_b32 v102, 0xffff0000, v25
    v_lshlrev_b32 v101, 16, v45
    v_and_b32 v103, 0xffff0000, v45
    v_pk_add_f32 v[8:9], v[8:9], v[100:101]
    v_pk_add_f32 v[8:9], v[8:9], v[102:103]
    v_lshlrev_b32 v104, 16, v26
    v_and_b32 v106, 0xffff0000, v26
    v_lshlrev_b32 v105, 16, v46
    v_and_b32 v107, 0xffff0000, v46
    v_pk_add_f32 v[8:9], v[8:9], v[104:105]
    v_pk_add_f32 v[8:9], v[8:9], v[106:107]
    v_lshlrev_b32 v108, 16, v27
    v_and_b32 v110, 0xffff0000, v27
    v_lshlrev_b32 v109, 16, v47
    v_and_b32 v111, 0xffff0000, v47
    v_pk_add_f32 v[8:9], v[8:9], v[108:109]
    v_pk_add_f32 v[8:9], v[8:9], v[110:111]
    s_waitcnt vmcnt(3)
    v_lshlrev_b32 v112, 16, v28
    v_and_b32 v114, 0xffff0000, v28
    v_lshlrev_b32 v113, 16, v48
    v_and_b32 v115, 0xffff0000, v48
    v_pk_add_f32 v[8:9], v[8:9], v[112:113]
    v_pk_add_f32 v[8:9], v[8:9], v[114:115]
    v_lshlrev_b32 v116, 16, v29
    v_and_b32 v118, 0xffff0000, v29
    v_lshlrev_b32 v117, 16, v49
    v_and_b32 v119, 0xffff0000, v49
    v_pk_add_f32 v[8:9], v[8:9], v[116:117]
    v_pk_add_f32 v[8:9], v[8:9], v[118:119]
    v_lshlrev_b32 v120, 16, v30
    v_and_b32 v122, 0xffff0000, v30
    v_lshlrev_b32 v121, 16, v50
    v_and_b32 v123, 0xffff0000, v50
    v_pk_add_f32 v[8:9], v[8:9], v[120:121]
    v_pk_add_f32 v[8:9], v[8:9], v[122:123]
    v_lshlrev_b32 v124, 16, v31
    v_and_b32 v126, 0xffff0000, v31
    v_lshlrev_b32 v125, 16, v51
    v_and_b32 v127, 0xffff0000, v51
    v_pk_add_f32 v[8:9], v[8:9], v[124:125]
    v_pk_add_f32 v[8:9], v[8:9], v[126:127]
    s_waitcnt vmcnt(1)
    v_lshlrev_b32 v128, 16, v32
    v_and_b32 v130, 0xffff0000, v32
    v_lshlrev_b32 v129, 16, v52
    v_and_b32 v131, 0xffff0000, v52
    v_pk_add_f32 v[8:9], v[8:9], v[128:129]
    v_pk_add_f32 v[8:9], v[8:9], v[130:131]
    v_lshlrev_b32 v132, 16, v33
    v_and_b32 v134, 0xffff0000, v33
    v_lshlrev_b32 v133, 16, v53
    v_and_b32 v135, 0xffff0000, v53
    v_pk_add_f32 v[8:9], v[8:9], v[132:133]
    v_pk_add_f32 v[8:9], v[8:9], v[134:135]
    v_lshlrev_b32 v136, 16, v34
    v_and_b32 v138, 0xffff0000, v34
    v_lshlrev_b32 v137, 16, v54
    v_and_b32 v139, 0xffff0000, v54
    v_pk_add_f32 v[8:9], v[8:9], v[136:137]
    v_pk_add_f32 v[8:9], v[8:9], v[138:139]
    v_lshlrev_b32 v140, 16, v35
    v_and_b32 v142, 0xffff0000, v35
    v_lshlrev_b32 v141, 16, v55
    v_and_b32 v143, 0xffff0000, v55
    v_pk_add_f32 v[8:9], v[8:9], v[140:141]
    v_pk_add_f32 v[8:9], v[8:9], v[142:143]
    s_cmp_lg_u32 s3, 5
    s_cbranch_scc1 L_PRE1
    s_and_b32 s72, s2, 1
    s_lshl_b32 s72, s72, 7
    v_mov_b32 v1, 0
    v_mov_b32 v2, 1
    s_mov_b64 exec, 1
    buffer_atomic_add v2, v1, s[48:51], s72 offen sc1
    s_mov_b64 exec, -1
L_PRE1:
    v_add_f32 v8, v8, v8 row_ror:8
    v_add_f32 v9, v9, v9 row_ror:8
    s_nop 0
    v_add_f32 v8, v8, v8 row_ror:4
    v_add_f32 v9, v9, v9 row_ror:4
    s_nop 0
    v_add_f32 v8, v8, v8 row_ror:2
    v_add_f32 v9, v9, v9 row_ror:2
    s_nop 0
    v_add_f32 v8, v8, v8 row_ror:1
    v_add_f32 v9, v9, v9 row_ror:1
    v_mul_f32 v8, 0x3acccccd, v8
    v_mul_f32 v9, 0x3acccccd, v9
    v_cvt_pk_bf16_f32 v10, v8, v9
    v_lshlrev_b32 v12, 16, v10
    v_and_b32 v13, 0xffff0000, v10
    v_sub_f32 v8, v8, v12
    v_sub_f32 v9, v9, v13
    v_mov_b32 v10, 0
    v_mov_b32 v11, 0
    v_pk_add_f32 v[64:65], v[64:65], v[12:13] neg_lo:[0,1] neg_hi:[0,1]
    v_pk_fma_f32 v[10:11], v[64:65], v[64:65], v[10:11]
    v_pk_add_f32 v[66:67], v[66:67], v[12:13] neg_lo:[0,1] neg_hi:[0,1]
    v_pk_fma_f32 v[10:11], v[66:67], v[66:67], v[10:11]
    v_pk_add_f32 v[68:69], v[68:69], v[12:13] neg_lo:[0,1] neg_hi:[0,1]
    v_pk_fma_f32 v[10:11], v[68:69], v[68:69], v[10:11]
    v_pk_add_f32 v[70:71], v[70:71], v[12:13] neg_lo:[0,1] neg_hi:[0,1]
    v_pk_fma_f32 v[10:11], v[70:71], v[70:71], v[10:11]
    v_pk_add_f32 v[72:73], v[72:73], v[12:13] neg_lo:[0,1] neg_hi:[0,1]
    v_pk_fma_f32 v[10:11], v[72:73], v[72:73], v[10:11]
    v_pk_add_f32 v[74:75], v[74:75], v[12:13] neg_lo:[0,1] neg_hi:[0,1]
    v_pk_fma_f32 v[10:11], v[74:75], v[74:75], v[10:11]
    v_pk_add_f32 v[76:77], v[76:77], v[12:13] neg_lo:[0,1] neg_hi:[0,1]
    v_pk_fma_f32 v[10:11], v[76:77], v[76:77], v[10:11]
    v_pk_add_f32 v[78:79], v[78:79], v[12:13] neg_lo:[0,1] neg_hi:[0,1]
    v_pk_fma_f32 v[10:11], v[78:79], v[78:79], v[10:11]
    v_pk_add_f32 v[80:81], v[80:81], v[12:13] neg_lo:[0,1] neg_hi:[0,1]
    v_pk_fma_f32 v[10:11], v[80:81], v[80:81], v[10:11]
    v_pk_add_f32 v[82:83], v[82:83], v[12:13] neg_lo:[0,1] neg_hi:[0,1]
    v_pk_fma_f32 v[10:11], v[82:83], v[82:83], v[10:11]
    v_pk_add_f32 v[84:85], v[84:85], v[12:13] neg_lo:[0,1] neg_hi:[0,1]
    v_pk_fma_f32 v[10:11], v[84:85], v[84:85], v[10:11]
    v_pk_add_f32 v[86:87], v[86:87], v[12:13] neg_lo:[0,1] neg_hi:[0,1]
    v_pk_fma_f32 v[10:11], v[86:87], v[86:87], v[10:11]
    v_pk_add_f32 v[88:89], v[88:89], v[12:13] neg_lo:[0,1] neg_hi:[0,1]
    v_pk_fma_f32 v[10:11], v[88:89], v[88:89], v[10:11]
    v_pk_add_f32 v[90:91], v[90:91], v[12:13] neg_lo:[0,1] neg_hi:[0,1]
    v_pk_fma_f32 v[10:11], v[90:91], v[90:91], v[10:11]
    v_pk_add_f32 v[92:93], v[92:93], v[12:13] neg_lo:[0,1] neg_hi:[0,1]
    v_pk_fma_f32 v[10:11], v[92:93], v[92:93], v[10:11]
    v_pk_add_f32 v[94:95], v[94:95], v[12:13] neg_lo:[0,1] neg_hi:[0,1]
    v_pk_fma_f32 v[10:11], v[94:95], v[94:95], v[10:11]
    v_pk_add_f32 v[96:97], v[96:97], v[12:13] neg_lo:[0,1] neg_hi:[0,1]
    v_pk_fma_f32 v[10:11], v[96:97], v[96:97], v[10:11]
    v_pk_add_f32 v[98:99], v[98:99], v[12:13] neg_lo:[0,1] neg_hi:[0,1]
    v_pk_fma_f32 v[10:11], v[98:99], v[98:99], v[10:11]
    v_pk_add_f32 v[100:101], v[100:101], v[12:13] neg_lo:[0,1] neg_hi:[0,1]
    v_pk_fma_f32 v[10:11], v[100:101], v[100:101], v[10:11]
    v_pk_add_f32 v[102:103], v[102:103], v[12:13] neg_lo:[0,1] neg_hi:[0,1]
    v_pk_fma_f32 v[10:11], v[102:103], v[102:103], v[10:11]
    v_pk_add_f32 v[104:105], v[104:105], v[12:13] neg_lo:[0,1] neg_hi:[0,1]
    v_pk_fma_f32 v[10:11], v[104:105], v[104:105], v[10:11]
    v_pk_add_f32 v[106:107], v[106:107], v[12:13] neg_lo:[0,1] neg_hi:[0,1]
    v_pk_fma_f32 v[10:11], v[106:107], v[106:107], v[10:11]
    v_pk_add_f32 v[108:109], v[108:109], v[12:13] neg_lo:[0,1] neg_hi:[0,1]
    v_pk_fma_f32 v[10:11], v[108:109], v[108:109], v[10:11]
    v_pk_add_f32 v[110:111], v[110:111], v[12:13] neg_lo:[0,1] neg_hi:[0,1]
    v_pk_fma_f32 v[10:11], v[110:111], v[110:111], v[10:11]
    v_pk_add_f32 v[112:113], v[112:113], v[12:13] neg_lo:[0,1] neg_hi:[0,1]
    v_pk_fma_f32 v[10:11], v[112:113], v[112:113], v[10:11]
    v_pk_add_f32 v[114:115], v[114:115], v[12:13] neg_lo:[0,1] neg_hi:[0,1]
    v_pk_fma_f32 v[10:11], v[114:115], v[114:115], v[10:11]
    v_pk_add_f32 v[116:117], v[116:117], v[12:13] neg_lo:[0,1] neg_hi:[0,1]
    v_pk_fma_f32 v[10:11], v[116:117], v[116:117], v[10:11]
    v_pk_add_f32 v[118:119], v[118:119], v[12:13] neg_lo:[0,1] neg_hi:[0,1]
    v_pk_fma_f32 v[10:11], v[118:119], v[118:119], v[10:11]
    v_pk_add_f32 v[120:121], v[120:121], v[12:13] neg_lo:[0,1] neg_hi:[0,1]
    v_pk_fma_f32 v[10:11], v[120:121], v[120:121], v[10:11]
    v_pk_add_f32 v[122:123], v[122:123], v[12:13] neg_lo:[0,1] neg_hi:[0,1]
    v_pk_fma_f32 v[10:11], v[122:123], v[122:123], v[10:11]
    v_pk_add_f32 v[124:125], v[124:125], v[12:13] neg_lo:[0,1] neg_hi:[0,1]
    v_pk_fma_f32 v[10:11], v[124:125], v[124:125], v[10:11]
    v_pk_add_f32 v[126:127], v[126:127], v[12:13] neg_lo:[0,1] neg_hi:[0,1]
    v_pk_fma_f32 v[10:11], v[126:127], v[126:127], v[10:11]
    v_pk_add_f32 v[128:129], v[128:129], v[12:13] neg_lo:[0,1] neg_hi:[0,1]
    v_pk_fma_f32 v[10:11], v[128:129], v[128:129], v[10:11]
    v_pk_add_f32 v[130:131], v[130:131], v[12:13] neg_lo:[0,1] neg_hi:[0,1]
    v_pk_fma_f32 v[10:11], v[130:131], v[130:131], v[10:11]
    v_pk_add_f32 v[132:133], v[132:133], v[12:13] neg_lo:[0,1] neg_hi:[0,1]
    v_pk_fma_f32 v[10:11], v[132:133], v[132:133], v[10:11]
    v_pk_add_f32 v[134:135], v[134:135], v[12:13] neg_lo:[0,1] neg_hi:[0,1]
    v_pk_fma_f32 v[10:11], v[134:135], v[134:135], v[10:11]
    v_pk_add_f32 v[136:137], v[136:137], v[12:13] neg_lo:[0,1] neg_hi:[0,1]
    v_pk_fma_f32 v[10:11], v[136:137], v[136:137], v[10:11]
    v_pk_add_f32 v[138:139], v[138:139], v[12:13] neg_lo:[0,1] neg_hi:[0,1]
    v_pk_fma_f32 v[10:11], v[138:139], v[138:139], v[10:11]
    v_pk_add_f32 v[140:141], v[140:141], v[12:13] neg_lo:[0,1] neg_hi:[0,1]
    v_pk_fma_f32 v[10:11], v[140:141], v[140:141], v[10:11]
    v_pk_add_f32 v[142:143], v[142:143], v[12:13] neg_lo:[0,1] neg_hi:[0,1]
    v_pk_fma_f32 v[10:11], v[142:143], v[142:143], v[10:11]
    v_bfe_u32 v58, v0, 1, 3
    v_and_b32 v59, 1, v0
    v_xor_b32 v58, v58, v4
    v_lshl_or_b32 v58, v58, 1, v59
    v_mul_u32_u24 v60, 1280, v4
    v_lshl_add_u32 v56, v58, 4, v60
    v_xor_b32 v57, 0x80, v56
    s_mul_i32 s72, s78, 40960
    s_lshl_b32 s73, s79, 8
    s_add_u32 s72, s72, s73
    s_add_u32 m0, s80, 0
    s_add_u32 s73, s72, 0
    buffer_load_dwordx4 v56, s[56:59], s73 offen lds
    s_add_u32 m0, s80, 1024
    s_add_u32 s73, s72, 5120
    buffer_load_dwordx4 v57, s[56:59], s73 offen lds
    s_add_u32 m0, s80, 2048
    s_add_u32 s73, s72, 10240
    buffer_load_dwordx4 v56, s[56:59], s73 offen lds
    s_add_u32 m0, s80, 3072
    s_add_u32 s73, s72, 15360
    buffer_load_dwordx4 v57, s[56:59], s73 offen lds
    s_add_u32 m0, s80, 4096
    s_add_u32 s73, s72, 20480
    buffer_load_dwordx4 v56, s[56:59], s73 offen lds
    s_add_u32 m0, s80, 5120
    s_add_u32 s73, s72, 25600
    buffer_load_dwordx4 v57, s[56:59], s73 offen lds
    s_add_u32 m0, s80, 6144
    s_add_u32 s73, s72, 30720
    buffer_load_dwordx4 v56, s[56:59], s73 offen lds
    s_add_u32 m0, s80, 7168
    s_add_u32 s73, s72, 35840
    buffer_load_dwordx4 v57, s[56:59], s73 offen lds
    v_add_f32 v10, v10, v10 row_ror:8
    v_add_f32 v11, v11, v11 row_ror:8
    s_nop 0
    v_add_f32 v10, v10, v10 row_ror:4
    v_add_f32 v11, v11, v11 row_ror:4
    s_nop 0
    v_add_f32 v10, v10, v10 row_ror:2
    v_add_f32 v11, v11, v11 row_ror:2
    s_nop 0
    v_add_f32 v10, v10, v10 row_ror:1
    v_add_f32 v11, v11, v11 row_ror:1
    v_mul_f32 v10, 0x3acccccd, v10
    v_mul_f32 v11, 0x3acccccd, v11
    v_fma_f32 v10, -v8, v8, v10
    v_fma_f32 v11, -v9, v9, v11
    v_max_f32 v10, 0, v10
    v_max_f32 v11, 0, v11
    v_cvt_pk_bf16_f32 v14, v10, v11
    v_lshlrev_b32 v10, 16, v14
    v_and_b32 v11, 0xffff0000, v14
    v_add_f32 v10, 0x3727c5ac, v10
    v_add_f32 v11, 0x3727c5ac, v11
    v_cvt_pk_bf16_f32 v14, v10, v11
    v_lshlrev_b32 v10, 16, v14
    v_and_b32 v11, 0xffff0000, v14
    v_sqrt_f32 v10, v10
    v_sqrt_f32 v11, v11
    s_nop 0
    v_cvt_pk_bf16_f32 v14, v10, v11
    v_lshlrev_b32 v17, 16, v14
    v_and_b32 v19, 0xffff0000, v14
    v_mov_b32 v16, v12
    v_mov_b32 v18, v13
    v_rcp_f32 v10, v17
    v_rcp_f32 v11, v19
    v_lshlrev_b32 v1, 4, v4
    v_mov_b32 v2, 33554432
    v_cmp_eq_u32 vcc, 0, v5
    s_nop 1
    v_cndmask_b32 v1, v2, v1, vcc
    s_lshl_b32 s72, s81, 3
    s_add_u32 s72, s72, 20971520
    s_cmp_lt_u32 s76, 32
    s_cselect_b32 s72, s72, 33554432
    buffer_store_dwordx4 v[16:19], v1, s[44:47], s72 offen sc1
    v_pk_mul_f32 v[64:65], v[64:65], v[10:11]
    v_cvt_pk_bf16_f32 v64, v64, v65
    ds_write_b32 v6, v64 offset:0
    v_pk_mul_f32 v[66:67], v[66:67], v[10:11]
    v_cvt_pk_bf16_f32 v66, v66, v67
    ds_write_b32 v6, v66 offset:128
    v_pk_mul_f32 v[68:69], v[68:69], v[10:11]
    v_cvt_pk_bf16_f32 v68, v68, v69
    ds_write_b32 v6, v68 offset:256
    v_pk_mul_f32 v[70:71], v[70:71], v[10:11]
    v_cvt_pk_bf16_f32 v70, v70, v71
    ds_write_b32 v6, v70 offset:384
    v_pk_mul_f32 v[72:73], v[72:73], v[10:11]
    v_cvt_pk_bf16_f32 v72, v72, v73
    ds_write_b32 v6, v72 offset:512
    v_pk_mul_f32 v[74:75], v[74:75], v[10:11]
    v_cvt_pk_bf16_f32 v74, v74, v75
    ds_write_b32 v6, v74 offset:640
    v_pk_mul_f32 v[76:77], v[76:77], v[10:11]
    v_cvt_pk_bf16_f32 v76, v76, v77
    ds_write_b32 v6, v76 offset:768
    v_pk_mul_f32 v[78:79], v[78:79], v[10:11]
    v_cvt_pk_bf16_f32 v78, v78, v79
    ds_write_b32 v6, v78 offset:896
    v_pk_mul_f32 v[80:81], v[80:81], v[10:11]
    v_cvt_pk_bf16_f32 v80, v80, v81
    ds_write_b32 v6, v80 offset:16384
    v_pk_mul_f32 v[82:83], v[82:83], v[10:11]
    v_cvt_pk_bf16_f32 v82, v82, v83
    ds_write_b32 v6, v82 offset:16512
    v_pk_mul_f32 v[84:85], v[84:85], v[10:11]
    v_cvt_pk_bf16_f32 v84, v84, v85
    ds_write_b32 v6, v84 offset:16640
    v_pk_mul_f32 v[86:87], v[86:87], v[10:11]
    v_cvt_pk_bf16_f32 v86, v86, v87
    ds_write_b32 v6, v86 offset:16768
    v_pk_mul_f32 v[88:89], v[88:89], v[10:11]
    v_cvt_pk_bf16_f32 v88, v88, v89
    ds_write_b32 v6, v88 offset:16896
    v_pk_mul_f32 v[90:91], v[90:91], v[10:11]
    v_cvt_pk_bf16_f32 v90, v90, v91
    ds_write_b32 v6, v90 offset:17024
    v_pk_mul_f32 v[92:93], v[92:93], v[10:11]
    v_cvt_pk_bf16_f32 v92, v92, v93
    ds_write_b32 v6, v92 offset:17152
    v_pk_mul_f32 v[94:95], v[94:95], v[10:11]
    v_cvt_pk_bf16_f32 v94, v94, v95
    ds_write_b32 v6, v94 offset:17280
    v_pk_mul_f32 v[96:97], v[96:97], v[10:11]
    v_cvt_pk_bf16_f32 v96, v96, v97
    ds_write_b32 v6, v96 offset:32768
    v_pk_mul_f32 v[98:99], v[98:99], v[10:11]
    v_cvt_pk_bf16_f32 v98, v98, v99
    ds_write_b32 v6, v98 offset:32896
    v_pk_mul_f32 v[100:101], v[100:101], v[10:11]
    v_cvt_pk_bf16_f32 v100, v100, v101
    ds_write_b32 v6, v100 offset:33024
    v_pk_mul_f32 v[102:103], v[102:103], v[10:11]
    v_cvt_pk_bf16_f32 v102, v102, v103
    ds_write_b32 v6, v102 offset:33152
    v_pk_mul_f32 v[104:105], v[104:105], v[10:11]
    v_cvt_pk_bf16_f32 v104, v104, v105
    ds_write_b32 v6, v104 offset:33280
    v_pk_mul_f32 v[106:107], v[106:107], v[10:11]
    v_cvt_pk_bf16_f32 v106, v106, v107
    ds_write_b32 v6, v106 offset:33408
    v_pk_mul_f32 v[108:109], v[108:109], v[10:11]
    v_cvt_pk_bf16_f32 v108, v108, v109
    ds_write_b32 v6, v108 offset:33536
    v_pk_mul_f32 v[110:111], v[110:111], v[10:11]
    v_cvt_pk_bf16_f32 v110, v110, v111
    ds_write_b32 v6, v110 offset:33664
    v_pk_mul_f32 v[112:113], v[112:113], v[10:11]
    v_cvt_pk_bf16_f32 v112, v112, v113
    ds_write_b32 v6, v112 offset:49152
    v_pk_mul_f32 v[114:115], v[114:115], v[10:11]
    v_cvt_pk_bf16_f32 v114, v114, v115
    ds_write_b32 v6, v114 offset:49280
    v_pk_mul_f32 v[116:117], v[116:117], v[10:11]
    v_cvt_pk_bf16_f32 v116, v116, v117
    ds_write_b32 v6, v116 offset:49408
    v_pk_mul_f32 v[118:119], v[118:119], v[10:11]
    v_cvt_pk_bf16_f32 v118, v118, v119
    ds_write_b32 v6, v118 offset:49536
    v_pk_mul_f32 v[120:121], v[120:121], v[10:11]
    v_cvt_pk_bf16_f32 v120, v120, v121
    ds_write_b32 v6, v120 offset:49664
    v_pk_mul_f32 v[122:123], v[122:123], v[10:11]
    v_cvt_pk_bf16_f32 v122, v122, v123
    ds_write_b32 v6, v122 offset:49792
    v_pk_mul_f32 v[124:125], v[124:125], v[10:11]
    v_cvt_pk_bf16_f32 v124, v124, v125
    ds_write_b32 v6, v124 offset:49920
    v_pk_mul_f32 v[126:127], v[126:127], v[10:11]
    v_cvt_pk_bf16_f32 v126, v126, v127
    ds_write_b32 v6, v126 offset:50048
    v_pk_mul_f32 v[128:129], v[128:129], v[10:11]
    v_cvt_pk_bf16_f32 v128, v128, v129
    ds_write_b32 v7, v128 offset:0
    v_pk_mul_f32 v[130:131], v[130:131], v[10:11]
    v_cvt_pk_bf16_f32 v130, v130, v131
    ds_write_b32 v7, v130 offset:128
    v_pk_mul_f32 v[132:133], v[132:133], v[10:11]
    v_cvt_pk_bf16_f32 v132, v132, v133
    ds_write_b32 v7, v132 offset:256
    v_pk_mul_f32 v[134:135], v[134:135], v[10:11]
    v_cvt_pk_bf16_f32 v134, v134, v135
    ds_write_b32 v7, v134 offset:384
    v_pk_mul_f32 v[136:137], v[136:137], v[10:11]
    v_cvt_pk_bf16_f32 v136, v136, v137
    ds_write_b32 v7, v136 offset:512
    v_pk_mul_f32 v[138:139], v[138:139], v[10:11]
    v_cvt_pk_bf16_f32 v138, v138, v139
    ds_write_b32 v7, v138 offset:640
    v_pk_mul_f32 v[140:141], v[140:141], v[10:11]
    v_cvt_pk_bf16_f32 v140, v140, v141
    ds_write_b32 v7, v140 offset:768
    v_pk_mul_f32 v[142:143], v[142:143], v[10:11]
    v_cvt_pk_bf16_f32 v142, v142, v143
    ds_write_b32 v7, v142 offset:896
    v_lshrrev_b32 v4, 3, v0
    v_and_b32 v5, 7, v0
    s_mul_i32 s72, s3, 10240
    v_lshlrev_b32 v6, 7, v4
    v_lshl_add_u32 v6, v5, 4, v6
    v_add_u32 v6, s72, v6
    v_lshlrev_b32 v7, 12, v4
    v_lshl_add_u32 v7, v5, 4, v7
    s_mul_i32 s73, s3, 327680
    s_lshl_b32 s74, s76, 7
    s_add_u32 s73, s73, s74
    s_add_u32 s73, s73, 8388608
    s_cmp_lt_u32 s76, 32
    s_cselect_b32 s73, s73, 33554432
    s_mul_i32 s74, s3, 10
    s_waitcnt vmcnt(0) lgkmcnt(0)
    s_barrier
    s_cmp_lg_u32 s3, 5
    s_cbranch_scc1 L_PRE0
    s_add_u32 s75, s82, 16384
    v_mov_b32 v1, 0
    v_mov_b32 v2, 1
    s_mov_b64 exec, 1
    buffer_store_dword v2, v1, s[44:47], s75 offen sc1
    s_mov_b64 exec, -1
L_PRE0:
    s_add_u32 s75, s74, 0
    s_and_b32 s75, s75, 7
    s_lshl_b32 s75, s75, 4
    v_xor_b32 v20, s75, v6
    ds_read_b128 v[64:67], v20 offset:0
    s_add_u32 s75, s74, 1
    s_and_b32 s75, s75, 7
    s_lshl_b32 s75, s75, 4
    v_xor_b32 v21, s75, v6
    ds_read_b128 v[68:71], v21 offset:1024
    s_add_u32 s75, s74, 2
    s_and_b32 s75, s75, 7
    s_lshl_b32 s75, s75, 4
    v_xor_b32 v22, s75, v6
    ds_read_b128 v[72:75], v22 offset:2048
    s_add_u32 s75, s74, 3
    s_and_b32 s75, s75, 7
    s_lshl_b32 s75, s75, 4
    v_xor_b32 v23, s75, v6
    ds_read_b128 v[76:79], v23 offset:3072
    s_add_u32 s75, s74, 4
    s_and_b32 s75, s75, 7
    s_lshl_b32 s75, s75, 4
    v_xor_b32 v24, s75, v6
    ds_read_b128 v[80:83], v24 offset:4096
    s_add_u32 s75, s74, 5
    s_and_b32 s75, s75, 7
    s_lshl_b32 s75, s75, 4
    v_xor_b32 v25, s75, v6
    ds_read_b128 v[84:87], v25 offset:5120
    s_add_u32 s75, s74, 6
    s_and_b32 s75, s75, 7
    s_lshl_b32 s75, s75, 4
    v_xor_b32 v26, s75, v6
    ds_read_b128 v[88:91], v26 offset:6144
    s_add_u32 s75, s74, 7
    s_and_b32 s75, s75, 7
    s_lshl_b32 s75, s75, 4
    v_xor_b32 v27, s75, v6
    ds_read_b128 v[92:95], v27 offset:7168
    s_add_u32 s75, s74, 8
    s_and_b32 s75, s75, 7
    s_lshl_b32 s75, s75, 4
    v_xor_b32 v28, s75, v6
    ds_read_b128 v[96:99], v28 offset:8192
    s_add_u32 s75, s74, 9
    s_and_b32 s75, s75, 7
    s_lshl_b32 s75, s75, 4
    v_xor_b32 v29, s75, v6
    ds_read_b128 v[100:103], v29 offset:9216
    s_waitcnt lgkmcnt(9)
    buffer_store_dwordx4 v[64:67], v7, s[44:47], s73 offen sc1
    s_add_u32 s73, s73, 32768
    s_waitcnt lgkmcnt(8)
    buffer_store_dwordx4 v[68:71], v7, s[44:47], s73 offen sc1
    s_add_u32 s73, s73, 32768
    s_waitcnt lgkmcnt(7)
    buffer_store_dwordx4 v[72:75], v7, s[44:47], s73 offen sc1
    s_add_u32 s73, s73, 32768
    s_waitcnt lgkmcnt(6)
    buffer_store_dwordx4 v[76:79], v7, s[44:47], s73 offen sc1
    s_add_u32 s73, s73, 32768
    s_waitcnt lgkmcnt(5)
    buffer_store_dwordx4 v[80:83], v7, s[44:47], s73 offen sc1
    s_add_u32 s73, s73, 32768
    s_waitcnt lgkmcnt(4)
    buffer_store_dwordx4 v[84:87], v7, s[44:47], s73 offen sc1
    s_add_u32 s73, s73, 32768
    s_waitcnt lgkmcnt(3)
    buffer_store_dwordx4 v[88:91], v7, s[44:47], s73 offen sc1
    s_add_u32 s73, s73, 32768
    s_waitcnt lgkmcnt(2)
    buffer_store_dwordx4 v[92:95], v7, s[44:47], s73 offen sc1
    s_add_u32 s73, s73, 32768
    s_waitcnt lgkmcnt(1)
    buffer_store_dwordx4 v[96:99], v7, s[44:47], s73 offen sc1
    s_add_u32 s73, s73, 32768
    s_waitcnt lgkmcnt(0)
    buffer_store_dwordx4 v[100:103], v7, s[44:47], s73 offen sc1
    s_add_u32 s73, s73, 32768
    v_lshrrev_b32 v4, 4, v0
    v_bfe_u32 v5, v0, 2, 2
    v_and_b32 v6, 3, v0
    v_and_b32 v7, 1, v4
    v_lshl_add_u32 v7, v7, 2, v5
    v_lshl_add_u32 v8, v4, 2, v5
    v_lshlrev_b32 v8, 8, v8
    v_lshl_add_u32 v8, v6, 3, v8
    v_lshl_add_u32 v12, v7, 5, v8
    v_add_u32 v12, s80, v12
    v_lshlrev_b32 v13, 4, v0
    v_xor_b32 v14, 0, v12
    ds_read_b64_tr_b16 v[104:105], v14
    ds_read_b64_tr_b16 v[106:107], v14 offset:4096
    v_xor_b32 v14, 32, v12
    ds_read_b64_tr_b16 v[108:109], v14
    ds_read_b64_tr_b16 v[110:111], v14 offset:4096
    v_xor_b32 v14, 64, v12
    ds_read_b64_tr_b16 v[112:113], v14
    ds_read_b64_tr_b16 v[114:115], v14 offset:4096
    v_xor_b32 v14, 96, v12
    ds_read_b64_tr_b16 v[116:117], v14
    ds_read_b64_tr_b16 v[118:119], v14 offset:4096
    v_xor_b32 v14, 128, v12
    ds_read_b64_tr_b16 v[120:121], v14
    ds_read_b64_tr_b16 v[122:123], v14 offset:4096
    v_xor_b32 v14, 160, v12
    ds_read_b64_tr_b16 v[124:125], v14
    ds_read_b64_tr_b16 v[126:127], v14 offset:4096
    v_xor_b32 v14, 192, v12
    ds_read_b64_tr_b16 v[128:129], v14
    ds_read_b64_tr_b16 v[130:131], v14 offset:4096
    v_xor_b32 v14, 224, v12
    ds_read_b64_tr_b16 v[132:133], v14
    ds_read_b64_tr_b16 v[134:135], v14 offset:4096
    s_mul_i32 s75, s78, 5120
    s_add_u32 s75, s75, 12582912
    s_cmp_lt_u32 s78, 54
    s_cselect_b32 s75, s75, 33554432
    s_lshl_b32 s74, s79, 3
    s_add_u32 s72, s74, 0
    s_mul_i32 s73, s72, 52
    s_lshr_b32 s73, s73, 8
    s_mul_i32 s73, s73, 271360
    s_lshl_b32 s72, s72, 10
    s_add_u32 s72, s72, s73
    s_add_u32 s72, s72, s75
    s_waitcnt lgkmcnt(14)
    buffer_store_dwordx4 v[104:107], v13, s[44:47], s72 offen sc1
    s_add_u32 s72, s74, 1
    s_mul_i32 s73, s72, 52
    s_lshr_b32 s73, s73, 8
    s_mul_i32 s73, s73, 271360
    s_lshl_b32 s72, s72, 10
    s_add_u32 s72, s72, s73
    s_add_u32 s72, s72, s75
    s_waitcnt lgkmcnt(12)
    buffer_store_dwordx4 v[108:111], v13, s[44:47], s72 offen sc1
    s_add_u32 s72, s74, 2
    s_mul_i32 s73, s72, 52
    s_lshr_b32 s73, s73, 8
    s_mul_i32 s73, s73, 271360
    s_lshl_b32 s72, s72, 10
    s_add_u32 s72, s72, s73
    s_add_u32 s72, s72, s75
    s_waitcnt lgkmcnt(10)
    buffer_store_dwordx4 v[112:115], v13, s[44:47], s72 offen sc1
    s_add_u32 s72, s74, 3
    s_mul_i32 s73, s72, 52
    s_lshr_b32 s73, s73, 8
    s_mul_i32 s73, s73, 271360
    s_lshl_b32 s72, s72, 10
    s_add_u32 s72, s72, s73
    s_add_u32 s72, s72, s75
    s_waitcnt lgkmcnt(8)
    buffer_store_dwordx4 v[116:119], v13, s[44:47], s72 offen sc1
    s_add_u32 s72, s74, 4
    s_mul_i32 s73, s72, 52
    s_lshr_b32 s73, s73, 8
    s_mul_i32 s73, s73, 271360
    s_lshl_b32 s72, s72, 10
    s_add_u32 s72, s72, s73
    s_add_u32 s72, s72, s75
    s_waitcnt lgkmcnt(6)
    buffer_store_dwordx4 v[120:123], v13, s[44:47], s72 offen sc1
    s_add_u32 s72, s74, 5
    s_mul_i32 s73, s72, 52
    s_lshr_b32 s73, s73, 8
    s_mul_i32 s73, s73, 271360
    s_lshl_b32 s72, s72, 10
    s_add_u32 s72, s72, s73
    s_add_u32 s72, s72, s75
    s_waitcnt lgkmcnt(4)
    buffer_store_dwordx4 v[124:127], v13, s[44:47], s72 offen sc1
    s_add_u32 s72, s74, 6
    s_mul_i32 s73, s72, 52
    s_lshr_b32 s73, s73, 8
    s_mul_i32 s73, s73, 271360
    s_lshl_b32 s72, s72, 10
    s_add_u32 s72, s72, s73
    s_add_u32 s72, s72, s75
    s_waitcnt lgkmcnt(2)
    buffer_store_dwordx4 v[128:131], v13, s[44:47], s72 offen sc1
    s_add_u32 s72, s74, 7
    s_mul_i32 s73, s72, 52
    s_lshr_b32 s73, s73, 8
    s_mul_i32 s73, s73, 271360
    s_lshl_b32 s72, s72, 10
    s_add_u32 s72, s72, s73
    s_add_u32 s72, s72, s75
    s_waitcnt lgkmcnt(0)
    buffer_store_dwordx4 v[132:135], v13, s[44:47], s72 offen sc1
    s_waitcnt vmcnt(8)
    s_barrier
    s_cmp_lg_u32 s3, 5
    s_cbranch_scc1 L_PRE2
    v_mov_b32 v1, 0
    v_mov_b32 v2, 1
    s_mov_b64 exec, 1
    buffer_store_dword v2, v1, s[44:47], s82 offen sc1
    s_mov_b64 exec, -1
L_PRE2:
    s_waitcnt vmcnt(0)
    s_barrier
    s_cmp_lg_u32 s3, 5
    s_cbranch_scc1 L_PRE3
    s_add_u32 s82, s82, 8192
    v_mov_b32 v1, 0
    v_mov_b32 v2, 1
    s_mov_b64 exec, 1
    buffer_store_dword v2, v1, s[44:47], s82 offen sc1
    s_mov_b64 exec, -1
L_PRE3:
    s_cmp_lt_u32 s3, 4
    s_cbranch_scc1 L_G2S
    s_cmp_eq_u32 s3, 4
    s_cbranch_scc1 L_PRE4
    s_branch L_END
    v_mov_b32 v10, 163164
    s_mov_b32 s73, 200000
LW_71:
    ds_read_b32 v11, v10
    s_waitcnt lgkmcnt(0)
    v_readfirstlane_b32 s72, v11
    s_nop 1
    s_cmp_ge_u32 s72, 1
    s_cbranch_scc1 LWD_72
    s_sub_u32 s73, s73, 1
    s_cmp_eq_u32 s73, 0
    s_cbranch_scc1 LWD_72
    s_sleep 8
    s_branch LW_71
LWD_72:
    s_lshr_b32 s72, s76, 3
    s_mul_i32 s72, s72, 3
    s_add_u32 s72, s72, s3
    s_sub_u32 s72, s72, 5
    s_mul_i32 s72, s72, 147456
    s_add_u32 s72, s72, 12582912
    v_lshlrev_b32 v10, 7, v0
    buffer_load_dword v16, v10, s[44:47], s72 offen sc1
    s_add_u32 s72, s72, 8192
    buffer_load_dword v17, v10, s[44:47], s72 offen sc1
    s_add_u32 s72, s72, 8192
    buffer_load_dword v18, v10, s[44:47], s72 offen sc1
    s_add_u32 s72, s72, 8192
    buffer_load_dword v19, v10, s[44:47], s72 offen sc1
    s_add_u32 s72, s72, 8192
    buffer_load_dword v20, v10, s[44:47], s72 offen sc1
    s_add_u32 s72, s72, 8192
    buffer_load_dword v21, v10, s[44:47], s72 offen sc1
    s_add_u32 s72, s72, 8192
    buffer_load_dword v22, v10, s[44:47], s72 offen sc1
    s_add_u32 s72, s72, 8192
    buffer_load_dword v23, v10, s[44:47], s72 offen sc1
    s_add_u32 s72, s72, 8192
    buffer_load_dword v24, v10, s[44:47], s72 offen sc1
    s_add_u32 s72, s72, 8192
    buffer_load_dword v25, v10, s[44:47], s72 offen sc1
    s_add_u32 s72, s72, 8192
    buffer_load_dword v26, v10, s[44:47], s72 offen sc1
    s_add_u32 s72, s72, 8192
    buffer_load_dword v27, v10, s[44:47], s72 offen sc1
    s_add_u32 s72, s72, 8192
    buffer_load_dword v28, v10, s[44:47], s72 offen sc1
    s_add_u32 s72, s72, 8192
    buffer_load_dword v29, v10, s[44:47], s72 offen sc1
    s_add_u32 s72, s72, 8192
    buffer_load_dword v30, v10, s[44:47], s72 offen sc1
    s_add_u32 s72, s72, 8192
    buffer_load_dword v31, v10, s[44:47], s72 offen sc1
    s_add_u32 s72, s72, 8192
    buffer_load_dword v32, v10, s[44:47], s72 offen sc1
    s_add_u32 s72, s72, 8192
    buffer_load_dword v33, v10, s[44:47], s72 offen sc1
    s_add_u32 s72, s72, 8192
    s_branch L_END
L_PRE4:
    v_lshlrev_b32 v10, 2, v0
    s_mov_b32 s73, 200000
DW_73:
    buffer_load_dword v11, v10, s[48:51], 0 offen sc1
    s_waitcnt vmcnt(0)
    v_readlane_b32 s72, v11, 0
    s_nop 1
    s_cmp_lt_u32 s72, 128
    s_cbranch_scc1 DWN_75
    v_readlane_b32 s72, v11, 32
    s_nop 1
    s_cmp_lt_u32 s72, 128
    s_cbranch_scc1 DWN_75
    s_branch DWD_74
DWN_75:
    s_sub_u32 s73, s73, 1
    s_cmp_eq_u32 s73, 0
    s_cbranch_scc1 DWD_74
    s_sleep 32
    s_branch DW_73
DWD_74:
    v_mov_b32 v10, 163268
    v_mov_b32 v11, 1
    ds_write_b32 v10, v11
    s_branch L_HOUSE
L_END:
    s_endpgm
.p2align 7
L_TABLE:
.long 0,0,0,0,0,0,0,0
.long 1,1,1,1,1,1,1,1
.long 2,2,2,2,2,2,2,2
.long 3,3,3,3,3,3,3,3
.long 4,4,4,4,4,4,4,4
.long 5,5,5,5,5,5,5,5
.long 6,6,6,6,6,6,6,6
.long 7,7,7,7,7,7,7,7
.long 8,8,8,8,8,8,8,8
.long 9,9,9,9,9,9,9,9
.long 10,10,10,10,10,10,10,10
.long 11,11,11,11,11,11,11,11
L_CODE_END:
.section .rodata,"a"
.p2align 6
.amdhsa_kernel recurrent_scan__ssm_conv_s4d__geglu_ffn__prompt_kernel
  .amdhsa_next_free_vgpr 256
  .amdhsa_next_free_sgpr 102
  .amdhsa_accum_offset 256
  .amdhsa_group_segment_fixed_size 0
  .amdhsa_kernarg_size 112
  .amdhsa_user_sgpr_count 2
  .amdhsa_user_sgpr_kernarg_segment_ptr 1
  .amdhsa_system_sgpr_workgroup_id_x 1
  .amdhsa_float_denorm_mode_32 3
  .amdhsa_float_denorm_mode_16_64 3
.end_amdhsa_kernel
```
